```python
import torch

def _softmax(x, axis=-1):
    return torch.softmax(x, dim=axis)
def _gelu(x):
    return torch.nn.functional.gelu(x, approximate="tanh")
def _silu(x):
    return torch.nn.functional.silu(x)
def _sigmoid(x):
    return torch.sigmoid(x)
def _layernorm(x, axis=-1, eps=1e-5):
    m = x.mean(dim=axis, keepdim=True)
    v = x.var(dim=axis, keepdim=True, unbiased=False)
    return (x - m) / torch.sqrt(v + eps)
def _scatter_add(tgt, idx, src, axis=0):
    return tgt.clone().index_add_(axis, idx, src)
def _segment_sum(src, seg, n):
    out = torch.zeros((n,) + src.shape[1:], dtype=src.dtype)
    return out.index_add_(0, seg, src)
def _pad(x, pw):
    flat = tuple(v for pair in reversed(pw) for v in pair)
    return torch.nn.functional.pad(x, flat)

kernel_name = 'sequential_preLN__linear_attn_block__mixer_channel_mlp__prompt'

def setup_inputs():

    _w = (lambda a: (lambda t: t.to(torch.bfloat16) if t.is_floating_point() else t)(torch.as_tensor(a)))
    def _A_setup():
        B, S, D = 1, 2048, 640
        return {
            "x": _w((lambda *s: torch.randn(*s, dtype=torch.bfloat16) * 0.05)(B, S, D)),
            "wqkv": _w((lambda *s: torch.randn(*s, dtype=torch.bfloat16) * 0.1)(D, 3 * D)),
            "wo": _w((lambda *s: torch.randn(*s, dtype=torch.bfloat16) * 0.05)(D, D)),
        }
    _A_in = _A_setup()

    def _B_setup():
        B, S, D, F = 1, 2048, 640, 1728
        return {
            "x": _w((lambda *s: torch.randn(*s, dtype=torch.bfloat16) * 0.05)(B, S, D)),
            "w1": _w((lambda *s: torch.randn(*s, dtype=torch.bfloat16) * 3.2)(D, F) * (D ** -0.5)),
            "b1": _w((lambda *s: torch.randn(*s, dtype=torch.bfloat16) * 0.8)(F)),
            "w2": _w((lambda *s: torch.randn(*s, dtype=torch.bfloat16) * 0.05)(F, D) * (F ** -0.5)),
            "b2": _w((lambda *s: torch.randn(*s, dtype=torch.bfloat16) * 0.05)(D)),
        }
    _B_in = _B_setup()

    return {
        "A_x": _A_in["x"],
        "A_wqkv": _A_in["wqkv"],
        "A_wo": _A_in["wo"],
        "B_x": _B_in["x"],
        "B_w1": _B_in["w1"],
        "B_b1": _B_in["b1"],
        "B_w2": _B_in["w2"],
        "B_b2": _B_in["b2"],
    }

def reference(A_x, A_wqkv, A_wo, B_x, B_w1, B_b1, B_w2, B_b2):
    def _A_ref(x, wqkv, wo):
        B, S, D = x.shape
        H = 32; Dh = D // H
        qkv = (lambda x, *d: x.permute(*d))((x @ wqkv).reshape(B, S, 3, H, Dh), 2, 0, 3, 1, 4)
        q, k, v = qkv[0], qkv[1], qkv[2]
        phi = lambda t: torch.where(t > 0, t + 1, torch.exp(t)) + 1e-6
        pq, pk = phi(q), phi(k)
        kv = torch.einsum("bhsd,bhse->bhde", pk, v)
        z = torch.einsum("bhsd->bhd", pk)
        num = torch.einsum("bhqd,bhde->bhqe", pq, kv)
        den = torch.einsum("bhqd,bhd->bhq", pq, z)[..., None] + 1e-6
        o = num / den
        return (lambda x, *d: x.permute(*d))(o, 0, 2, 1, 3).reshape(B, S, D) @ wo

    def _B_ref(x, w1, b1, w2, b2):
        y = _layernorm(x, axis=-1)
        h = _gelu(torch.einsum("bsd,df->bsf", y, w1) + b1)
        return torch.einsum("bsf,fd->bsd", h, w2) + b2

    x = A_x
    h = x + _A_ref(_layernorm(x, axis=-1), A_wqkv, A_wo)
    h2 = h + _B_ref(_layernorm(h, axis=-1), B_w1, B_b1, B_w2, B_b2)
    return h2
```

```asm
; @launch grid=(256,1,1) block=(512,1,1) lds=163840
.amdgcn_target "amdgcn-amd-amdhsa--gfx950"
.text
.globl sequential_preLN__linear_attn_block__mixer_channel_mlp__prompt_kernel
.p2align 8
.type sequential_preLN__linear_attn_block__mixer_channel_mlp__prompt_kernel,@function
sequential_preLN__linear_attn_block__mixer_channel_mlp__prompt_kernel:
  s_cmp_ge_u32 s2, 256
  s_cbranch_scc1 L_end
  s_load_dwordx16 s[4:19], s[0:1], 0
  s_load_dwordx4 s[20:23], s[0:1], 64
  s_load_dwordx2 s[24:25], s[0:1], 80
  s_getpc_b64 s[78:79]
  s_lshr_b32 s82, s2, 3
  v_lshrrev_b32 v16, 5, v0
  s_lshl_b32 s76, s82, 11
  v_lshl_add_u32 v17, v16, 7, s76
  v_min_u32 v17, 32304, v17
  s_mov_b32 exec_lo, 1
  s_mov_b32 exec_hi, 1
  global_load_dword v14, v17, s[78:79]
  s_mov_b64 exec, -1
  v_lshrrev_b32 v16, 6, v0
  v_and_b32 v1, 63, v0
  v_readfirstlane_b32 s26, v16
  s_and_b32 s72, s2, 7
  s_and_b32 s27, s72, 3
  s_lshl_b32 s27, s27, 2
  s_and_b32 s74, s82, 3
  s_add_u32 s27, s27, s74
  s_lshr_b32 s28, s72, 2
  s_lshl_b32 s28, s28, 3
  s_lshr_b32 s75, s82, 2
  s_add_u32 s28, s28, s75
  s_and_b32 s80, s26, 3
  s_lshr_b32 s81, s26, 2
  v_lshlrev_b32 v2, 4, v1
  s_mov_b32 s3, 1
  s_cmp_ge_u32 s26, 4
  s_cbranch_scc1 L_p1c
  v_lshrrev_b32 v16, 3, v1
  v_and_b32 v17, 7, v1
  v_lshrrev_b32 v18, 4, v1
  s_lshl_b32 s76, s80, 5
  v_add_u32 v19, s76, v16
  v_mul_u32_u24 v19, 1280, v19
  v_xor_b32 v24, v17, v18
  v_lshl_add_u32 v24, v24, 4, v19
  v_xor_b32 v25, 64, v24
  v_add_u32 v25, 9216, v25
  v_add_u32 v26, 18432, v24
  v_add_u32 v27, 18432, v25
  s_mul_i32 s78, s27, 163840
  s_lshl_b32 s94, s80, 12
  s_lshl_b32 s95, s80, 11
  s_mul_i32 s101, s74, 3
  s_add_u32 s101, s101, s75
  s_and_b32 s79, s72, 3
  s_add_u32 s101, s101, s79
  s_lshr_b32 s79, s72, 2
  s_lshl_b32 s79, s79, 1
  s_add_u32 s101, s101, s79
  s_cmp_ge_u32 s101, 10
  s_cselect_b32 s79, 10, 0
  s_sub_u32 s101, s101, s79
  s_cmp_ge_u32 s101, 10
  s_cselect_b32 s79, 10, 0
  s_sub_u32 s101, s101, s79
  s_lshl_b32 s76, s80, 4
  v_add_u32 v19, s76, v16
  v_mul_u32_u24 v19, 3840, v19
  v_and_b32 v18, 1, v18
  v_lshlrev_b32 v18, 1, v18
  v_xor_b32 v17, v17, v18
  v_lshl_add_u32 v19, v17, 4, v19
  v_xor_b32 v16, 64, v19
  v_add_u32 v16, 29696, v16
  s_mul_i32 s77, s28, 80
  s_and_b32 s77, s77, 0xffffffc0
  s_add_u32 s77, s77, 1280
  v_add_u32 v28, s77, v19
  v_add_u32 v29, s77, v16
  s_add_u32 s77, s77, 1280
  v_xor_b32 v17, 16, v19
  v_xor_b32 v18, 16, v16
  v_add_u32 v30, s77, v17
  v_add_u32 v31, s77, v18
  s_waitcnt lgkmcnt(0)
  s_add_u32 s32, s4, s78
  s_addc_u32 s33, s5, 0
  s_mov_b32 s34, 163840
  s_mov_b32 s35, 0x20000
  s_mov_b32 s36, s6
  s_mov_b32 s37, s7
  s_mov_b32 s38, 2457600
  s_mov_b32 s39, 0x20000
  s_lshl_b32 s96, s101, 7
  s_mul_i32 s97, s101, 245760
  s_add_u32 m0, s94, 0
  s_add_u32 s101, s101, 1
  s_cmp_eq_u32 s101, 10
  s_cselect_b32 s101, 0, s101
  buffer_load_dwordx4 v24, s[32:35], s96 offen lds
  buffer_load_dwordx4 v25, s[32:35], s96 offen offset:1024 lds
  buffer_load_dwordx4 v26, s[32:35], s96 offen offset:2048 lds
  buffer_load_dwordx4 v27, s[32:35], s96 offen offset:3072 lds
  s_add_u32 m0, s95, 16384
  s_nop 0
  buffer_load_dwordx4 v28, s[36:39], s97 offen offset:0 lds
  buffer_load_dwordx4 v29, s[36:39], s97 offen offset:1024 lds
  s_add_u32 m0, s95, 24576
  s_nop 0
  buffer_load_dwordx4 v30, s[36:39], s97 offen offset:0 lds
  buffer_load_dwordx4 v31, s[36:39], s97 offen offset:1024 lds
  s_xor_b32 s77, s28, 1
  s_mul_i32 s77, s77, 80
  s_and_b32 s77, s77, 0xffffffc0
  v_add_u32 v32, s77, v19
  v_add_u32 v33, s77, v16
  v_lshrrev_b32 v20, 4, v1
  v_and_b32 v23, 15, v1
  s_lshl_b32 s76, s80, 12
  v_lshrrev_b32 v16, 1, v23
  v_xor_b32 v16, v16, v20
  v_lshlrev_b32 v16, 4, v16
  v_lshl_add_u32 v16, v23, 7, v16
  v_add_u32 v8, s76, v16
  v_xor_b32 v9, 64, v8
  v_add_u32 v10, 65536, v8
  v_add_u32 v11, 65536, v9
  v_mov_b32 v4, 0x3f803f80
  v_mov_b32 v5, 0x3f803f80
  v_mov_b32 v6, 0x3f803f80
  v_mov_b32 v7, 0x3f803f80
  s_lshl_b32 s96, s101, 7
  s_mul_i32 s97, s101, 245760
  s_add_u32 m0, s94, 32768
  s_add_u32 s101, s101, 1
  s_cmp_eq_u32 s101, 10
  s_cselect_b32 s101, 0, s101
  buffer_load_dwordx4 v24, s[32:35], s96 offen lds
  buffer_load_dwordx4 v25, s[32:35], s96 offen offset:1024 lds
  buffer_load_dwordx4 v26, s[32:35], s96 offen offset:2048 lds
  buffer_load_dwordx4 v27, s[32:35], s96 offen offset:3072 lds
  s_add_u32 m0, s95, 49152
  s_nop 0
  buffer_load_dwordx4 v28, s[36:39], s97 offen offset:0 lds
  buffer_load_dwordx4 v29, s[36:39], s97 offen offset:1024 lds
  s_add_u32 m0, s95, 57344
  s_nop 0
  buffer_load_dwordx4 v30, s[36:39], s97 offen offset:0 lds
  buffer_load_dwordx4 v31, s[36:39], s97 offen offset:1024 lds
  s_waitcnt vmcnt(8)
  s_barrier
  ds_read_b128 v[44:47], v8 offset:0
  ds_read_b128 v[48:51], v8 offset:2048
  ds_read_b128 v[52:55], v9 offset:0
  ds_read_b128 v[56:59], v9 offset:2048
  s_lshl_b32 s96, s101, 7
  s_mul_i32 s97, s101, 245760
  s_add_u32 m0, s94, 65536
  s_add_u32 s101, s101, 1
  s_cmp_eq_u32 s101, 10
  s_cselect_b32 s101, 0, s101
  buffer_load_dwordx4 v24, s[32:35], s96 offen lds
  buffer_load_dwordx4 v25, s[32:35], s96 offen offset:1024 lds
  s_waitcnt lgkmcnt(3)
  v_mfma_f32_16x16x32_bf16 v[204:207], v[44:47], v[44:47], 0
  buffer_load_dwordx4 v26, s[32:35], s96 offen offset:2048 lds
  v_mfma_f32_16x16x32_bf16 v[212:215], v[4:7], v[44:47], 0
  buffer_load_dwordx4 v27, s[32:35], s96 offen offset:3072 lds
  s_add_u32 m0, s95, 81920
  s_waitcnt lgkmcnt(2)
  v_mfma_f32_16x16x32_bf16 v[208:211], v[48:51], v[48:51], 0
  buffer_load_dwordx4 v28, s[36:39], s97 offen offset:0 lds
  v_mfma_f32_16x16x32_bf16 v[216:219], v[4:7], v[48:51], 0
  buffer_load_dwordx4 v29, s[36:39], s97 offen offset:1024 lds
  s_add_u32 m0, s95, 90112
  s_waitcnt lgkmcnt(1)
  v_mfma_f32_16x16x32_bf16 v[204:207], v[52:55], v[52:55], v[204:207]
  buffer_load_dwordx4 v30, s[36:39], s97 offen offset:0 lds
  v_mfma_f32_16x16x32_bf16 v[212:215], v[4:7], v[52:55], v[212:215]
  buffer_load_dwordx4 v31, s[36:39], s97 offen offset:1024 lds
  s_waitcnt lgkmcnt(0)
  v_mfma_f32_16x16x32_bf16 v[208:211], v[56:59], v[56:59], v[208:211]
  v_mfma_f32_16x16x32_bf16 v[216:219], v[4:7], v[56:59], v[216:219]
  s_mov_b32 s52, s24
  s_mov_b32 s53, s25
  s_mov_b32 s54, 33554432
  s_mov_b32 s55, 0x20000
  s_and_b32 s72, s2, 7
  s_lshl_b32 s29, s72, 1
  s_and_b32 s76, s82, 1
  s_add_u32 s29, s29, s76
  s_lshr_b32 s30, s82, 1
  s_and_b32 s31, s30, 7
  s_and_b32 s88, s31, 1
  s_lshl_b32 s83, s29, 3
  s_lshr_b32 s76, s30, 3
  s_lshl_b32 s76, s76, 2
  s_add_u32 s83, s83, s76
  s_add_u32 s83, s83, s80
  s_lshl_b32 s76, s88, 5
  s_lshl_b32 s77, s81, 6
  s_add_u32 s84, s76, s77
  s_xor_b32 s77, s77, 64
  s_add_u32 s85, s76, s77
  s_cmp_eq_u32 s88, 0
  s_cselect_b32 s86, 128, 0
  s_mul_i32 s87, s83, 20480
  s_mul_i32 s76, s31, 160
  s_add_u32 s87, s87, s76
  s_lshl_b32 s89, s26, 10
  s_sub_u32 s77, 819200, s76
  s_sub_u32 s78, 1280, s76
  s_add_u32 s40, s8, s76
  s_addc_u32 s41, s9, 0
  s_mov_b32 s42, s77
  s_mov_b32 s43, 0x20000
  s_add_u32 s68, s18, s76
  s_addc_u32 s69, s19, 0
  s_mov_b32 s70, s78
  s_mov_b32 s71, 0x20000
  s_mov_b32 s60, s22
  s_mov_b32 s61, s23
  s_mov_b32 s62, 256
  s_mov_b32 s63, 0x20000
  s_mov_b32 s56, s20
  s_mov_b32 s57, s21
  s_mov_b32 s58, 2621440
  s_mov_b32 s59, 0x20000
  v_mov_b32 v4, 0x3f803f80
  v_mov_b32 v5, 0x3f803f80
  v_mov_b32 v6, 0x3f803f80
  v_mov_b32 v7, 0x3f803f80
  v_and_b32 v16, 15, v1
  v_mul_u32_u24 v16, 1280, v16
  v_lshrrev_b32 v17, 4, v1
  v_lshl_add_u32 v3, v17, 3, v16
  s_waitcnt vmcnt(8)
  s_barrier
  ds_read_b128 v[60:63], v8 offset:32768
  ds_read_b128 v[64:67], v8 offset:34816
  ds_read_b128 v[68:71], v9 offset:32768
  ds_read_b128 v[72:75], v9 offset:34816
  s_lshl_b32 s96, s101, 7
  s_mul_i32 s97, s101, 245760
  s_add_u32 m0, s94, 98304
  s_add_u32 s101, s101, 1
  s_cmp_eq_u32 s101, 10
  s_cselect_b32 s101, 0, s101
  buffer_load_dwordx4 v24, s[32:35], s96 offen lds
  buffer_load_dwordx4 v25, s[32:35], s96 offen offset:1024 lds
  s_waitcnt lgkmcnt(3)
  v_mfma_f32_16x16x32_bf16 v[204:207], v[60:63], v[60:63], v[204:207]
  buffer_load_dwordx4 v26, s[32:35], s96 offen offset:2048 lds
  v_mfma_f32_16x16x32_bf16 v[212:215], v[4:7], v[60:63], v[212:215]
  buffer_load_dwordx4 v27, s[32:35], s96 offen offset:3072 lds
  s_add_u32 m0, s95, 114688
  s_waitcnt lgkmcnt(2)
  v_mfma_f32_16x16x32_bf16 v[208:211], v[64:67], v[64:67], v[208:211]
  buffer_load_dwordx4 v28, s[36:39], s97 offen offset:0 lds
  v_mfma_f32_16x16x32_bf16 v[216:219], v[4:7], v[64:67], v[216:219]
  buffer_load_dwordx4 v29, s[36:39], s97 offen offset:1024 lds
  s_add_u32 m0, s95, 122880
  s_waitcnt lgkmcnt(1)
  v_mfma_f32_16x16x32_bf16 v[204:207], v[68:71], v[68:71], v[204:207]
  buffer_load_dwordx4 v30, s[36:39], s97 offen offset:0 lds
  v_mfma_f32_16x16x32_bf16 v[212:215], v[4:7], v[68:71], v[212:215]
  buffer_load_dwordx4 v31, s[36:39], s97 offen offset:1024 lds
  s_waitcnt lgkmcnt(0)
  v_mfma_f32_16x16x32_bf16 v[208:211], v[72:75], v[72:75], v[208:211]
  v_mfma_f32_16x16x32_bf16 v[216:219], v[4:7], v[72:75], v[216:219]
  v_lshrrev_b32 v20, 4, v1
  v_bfe_u32 v21, v1, 2, 2
  v_and_b32 v22, 3, v1
  v_lshl_add_u32 v16, v20, 3, v21
  v_lshlrev_b32 v16, 7, v16
  v_and_b32 v17, 1, v20
  v_lshlrev_b32 v17, 1, v17
  v_lshrrev_b32 v18, 1, v21
  v_or_b32 v17, v17, v18
  v_lshlrev_b32 v17, 5, v17
  v_and_b32 v23, 1, v22
  v_mul_u32_u24 v23, 40, v23
  s_xor_b32 s76, s28, 1
  s_and_b32 s76, s76, 3
  s_lshl_b32 s76, s76, 4
  s_mov_b32 s77, 65536
  v_lshl_add_u32 v18, v22, 3, s76
  v_xor_b32 v19, v18, v17
  v_add3_u32 v35, v19, v16, s77
  v_add_u32 v18, 40, v18
  v_xor_b32 v19, v18, v17
  v_add3_u32 v36, v19, v16, s77
  v_add3_u32 v18, v23, s76, 32
  v_xor_b32 v19, v18, v17
  v_add3_u32 v34, v19, v16, s77
  v_add_u32 v37, 65536, v34
  v_add_u32 v38, 65536, v35
  v_add_u32 v39, 65536, v36
  s_mov_b32 s90, 0x22222222
  s_mov_b32 s91, 0x22222222
  s_mov_b32 s92, 0x44444444
  s_mov_b32 s93, 0x44444444
  s_mov_b32 s74, 0x88888888
  s_mov_b32 s75, 0x88888888
  s_mov_b32 s72, 0x00f0000f
  s_mov_b32 s73, 0xf0000f00
  v_and_b32 v16, 15, v1
  v_lshlrev_b32 v16, 2, v16
  s_lshl_b32 s76, s80, 7
  s_add_u32 s76, s76, 156672
  v_add_u32 v40, s76, v16
  v_mov_b32 v41, 0
  v_mov_b32 v12, 155648
  v_mov_b32 v13, 1
  s_waitcnt vmcnt(8)
  s_barrier
  ds_read_b128 v[76:79], v10 offset:0
  ds_read_b128 v[80:83], v10 offset:2048
  ds_read_b128 v[84:87], v11 offset:0
  ds_read_b128 v[88:91], v11 offset:2048
  s_lshl_b32 s96, s101, 7
  s_mul_i32 s97, s101, 245760
  s_add_u32 m0, s94, 0
  s_add_u32 s101, s101, 1
  s_cmp_eq_u32 s101, 10
  s_cselect_b32 s101, 0, s101
  buffer_load_dwordx4 v24, s[32:35], s96 offen lds
  buffer_load_dwordx4 v25, s[32:35], s96 offen offset:1024 lds
  s_waitcnt lgkmcnt(3)
  v_mfma_f32_16x16x32_bf16 v[204:207], v[76:79], v[76:79], v[204:207]
  buffer_load_dwordx4 v26, s[32:35], s96 offen offset:2048 lds
  v_mfma_f32_16x16x32_bf16 v[212:215], v[4:7], v[76:79], v[212:215]
  buffer_load_dwordx4 v27, s[32:35], s96 offen offset:3072 lds
  s_add_u32 m0, s95, 16384
  s_waitcnt lgkmcnt(2)
  v_mfma_f32_16x16x32_bf16 v[208:211], v[80:83], v[80:83], v[208:211]
  buffer_load_dwordx4 v28, s[36:39], s97 offen offset:0 lds
  v_mfma_f32_16x16x32_bf16 v[216:219], v[4:7], v[80:83], v[216:219]
  buffer_load_dwordx4 v29, s[36:39], s97 offen offset:1024 lds
  s_add_u32 m0, s95, 24576
  s_waitcnt lgkmcnt(1)
  v_mfma_f32_16x16x32_bf16 v[204:207], v[84:87], v[84:87], v[204:207]
  buffer_load_dwordx4 v30, s[36:39], s97 offen offset:0 lds
  v_mfma_f32_16x16x32_bf16 v[212:215], v[4:7], v[84:87], v[212:215]
  buffer_load_dwordx4 v31, s[36:39], s97 offen offset:1024 lds
  s_waitcnt lgkmcnt(0)
  v_mfma_f32_16x16x32_bf16 v[208:211], v[88:91], v[88:91], v[208:211]
  v_mfma_f32_16x16x32_bf16 v[216:219], v[4:7], v[88:91], v[216:219]
  s_lshl_b32 s77, s82, 2
  s_add_u32 s77, s77, s80
  s_lshl_b32 s10, s77, 13
  s_lshl_b32 s78, s2, 2
  s_add_u32 s78, s78, s80
  s_movk_i32 s100, 3456
  s_movk_i32 s11, 2428
  s_cmp_lt_u32 s78, 540
  s_cselect_b32 s48, s16, s12
  s_cselect_b32 s49, s17, s13
  s_mov_b32 s50, 2211840
  s_mov_b32 s51, 0x20000
  s_cselect_b32 s100, 1280, s100
  s_cselect_b32 s77, 0, 540
  s_cselect_b32 s11, 6554, s11
  s_sub_u32 s77, s78, s77
  s_mul_i32 s11, s11, s77
  s_lshr_b32 s11, s11, 16
  s_mul_i32 s11, s11, s100
  s_mul_i32 s11, s11, 31
  s_lshl_b32 s77, s77, 7
  s_add_u32 s11, s11, s77
  s_mov_b32 s64, s8
  s_mov_b32 s65, s9
  s_mov_b32 s66, 819200
  s_mov_b32 s67, 0x20000
  s_waitcnt vmcnt(8)
  s_barrier
  ds_read_b128 v[92:95], v10 offset:32768
  ds_read_b128 v[96:99], v10 offset:34816
  ds_read_b128 v[100:103], v11 offset:32768
  ds_read_b128 v[104:107], v11 offset:34816
  s_lshl_b32 s96, s101, 7
  s_mul_i32 s97, s101, 245760
  s_add_u32 m0, s94, 32768
  s_add_u32 s101, s101, 1
  s_cmp_eq_u32 s101, 10
  s_cselect_b32 s101, 0, s101
  buffer_load_dwordx4 v24, s[32:35], s96 offen lds
  buffer_load_dwordx4 v25, s[32:35], s96 offen offset:1024 lds
  s_waitcnt lgkmcnt(3)
  v_mfma_f32_16x16x32_bf16 v[204:207], v[92:95], v[92:95], v[204:207]
  buffer_load_dwordx4 v26, s[32:35], s96 offen offset:2048 lds
  v_mfma_f32_16x16x32_bf16 v[212:215], v[4:7], v[92:95], v[212:215]
  buffer_load_dwordx4 v27, s[32:35], s96 offen offset:3072 lds
  s_add_u32 m0, s95, 49152
  s_waitcnt lgkmcnt(2)
  v_mfma_f32_16x16x32_bf16 v[208:211], v[96:99], v[96:99], v[208:211]
  buffer_load_dwordx4 v28, s[36:39], s97 offen offset:0 lds
  v_mfma_f32_16x16x32_bf16 v[216:219], v[4:7], v[96:99], v[216:219]
  buffer_load_dwordx4 v29, s[36:39], s97 offen offset:1024 lds
  s_add_u32 m0, s95, 57344
  s_waitcnt lgkmcnt(1)
  v_mfma_f32_16x16x32_bf16 v[204:207], v[100:103], v[100:103], v[204:207]
  buffer_load_dwordx4 v30, s[36:39], s97 offen offset:0 lds
  v_mfma_f32_16x16x32_bf16 v[212:215], v[4:7], v[100:103], v[212:215]
  buffer_load_dwordx4 v31, s[36:39], s97 offen offset:1024 lds
  s_waitcnt lgkmcnt(0)
  v_mfma_f32_16x16x32_bf16 v[208:211], v[104:107], v[104:107], v[208:211]
  v_mfma_f32_16x16x32_bf16 v[216:219], v[4:7], v[104:107], v[216:219]
  s_waitcnt vmcnt(8)
  s_barrier
  ds_read_b128 v[108:111], v8 offset:0
  ds_read_b128 v[112:115], v8 offset:2048
  ds_read_b128 v[116:119], v9 offset:0
  ds_read_b128 v[120:123], v9 offset:2048
  s_lshl_b32 s96, s101, 7
  s_mul_i32 s97, s101, 245760
  s_add_u32 m0, s94, 65536
  s_add_u32 s101, s101, 1
  s_cmp_eq_u32 s101, 10
  s_cselect_b32 s101, 0, s101
  buffer_load_dwordx4 v24, s[32:35], s96 offen lds
  buffer_load_dwordx4 v25, s[32:35], s96 offen offset:1024 lds
  s_waitcnt lgkmcnt(3)
  v_mfma_f32_16x16x32_bf16 v[204:207], v[108:111], v[108:111], v[204:207]
  buffer_load_dwordx4 v26, s[32:35], s96 offen offset:2048 lds
  v_mfma_f32_16x16x32_bf16 v[212:215], v[4:7], v[108:111], v[212:215]
  buffer_load_dwordx4 v27, s[32:35], s96 offen offset:3072 lds
  s_add_u32 m0, s95, 81920
  s_waitcnt lgkmcnt(2)
  v_mfma_f32_16x16x32_bf16 v[208:211], v[112:115], v[112:115], v[208:211]
  buffer_load_dwordx4 v28, s[36:39], s97 offen offset:0 lds
  v_mfma_f32_16x16x32_bf16 v[216:219], v[4:7], v[112:115], v[216:219]
  buffer_load_dwordx4 v29, s[36:39], s97 offen offset:1024 lds
  s_add_u32 m0, s95, 90112
  s_waitcnt lgkmcnt(1)
  v_mfma_f32_16x16x32_bf16 v[204:207], v[116:119], v[116:119], v[204:207]
  buffer_load_dwordx4 v30, s[36:39], s97 offen offset:0 lds
  v_mfma_f32_16x16x32_bf16 v[212:215], v[4:7], v[116:119], v[212:215]
  buffer_load_dwordx4 v31, s[36:39], s97 offen offset:1024 lds
  s_waitcnt lgkmcnt(0)
  v_mfma_f32_16x16x32_bf16 v[208:211], v[120:123], v[120:123], v[208:211]
  v_mfma_f32_16x16x32_bf16 v[216:219], v[4:7], v[120:123], v[216:219]
  s_waitcnt vmcnt(8)
  s_barrier
  ds_read_b128 v[124:127], v8 offset:32768
  ds_read_b128 v[128:131], v8 offset:34816
  ds_read_b128 v[132:135], v9 offset:32768
  ds_read_b128 v[136:139], v9 offset:34816
  s_lshl_b32 s96, s101, 7
  s_mul_i32 s97, s101, 245760
  s_add_u32 m0, s94, 98304
  s_add_u32 s101, s101, 1
  s_cmp_eq_u32 s101, 10
  s_cselect_b32 s101, 0, s101
  buffer_load_dwordx4 v24, s[32:35], s96 offen lds
  buffer_load_dwordx4 v25, s[32:35], s96 offen offset:1024 lds
  s_waitcnt lgkmcnt(3)
  v_mfma_f32_16x16x32_bf16 v[204:207], v[124:127], v[124:127], v[204:207]
  buffer_load_dwordx4 v26, s[32:35], s96 offen offset:2048 lds
  v_mfma_f32_16x16x32_bf16 v[212:215], v[4:7], v[124:127], v[212:215]
  buffer_load_dwordx4 v27, s[32:35], s96 offen offset:3072 lds
  s_add_u32 m0, s95, 114688
  s_waitcnt lgkmcnt(2)
  v_mfma_f32_16x16x32_bf16 v[208:211], v[128:131], v[128:131], v[208:211]
  buffer_load_dwordx4 v28, s[36:39], s97 offen offset:0 lds
  v_mfma_f32_16x16x32_bf16 v[216:219], v[4:7], v[128:131], v[216:219]
  buffer_load_dwordx4 v29, s[36:39], s97 offen offset:1024 lds
  s_add_u32 m0, s95, 122880
  s_waitcnt lgkmcnt(1)
  v_mfma_f32_16x16x32_bf16 v[204:207], v[132:135], v[132:135], v[204:207]
  buffer_load_dwordx4 v30, s[36:39], s97 offen offset:0 lds
  v_mfma_f32_16x16x32_bf16 v[212:215], v[4:7], v[132:135], v[212:215]
  buffer_load_dwordx4 v31, s[36:39], s97 offen offset:1024 lds
  s_waitcnt lgkmcnt(0)
  v_mfma_f32_16x16x32_bf16 v[208:211], v[136:139], v[136:139], v[208:211]
  v_mfma_f32_16x16x32_bf16 v[216:219], v[4:7], v[136:139], v[216:219]
  s_waitcnt vmcnt(8)
  s_barrier
  ds_read_b128 v[140:143], v10 offset:0
  ds_read_b128 v[144:147], v10 offset:2048
  ds_read_b128 v[148:151], v11 offset:0
  ds_read_b128 v[152:155], v11 offset:2048
  buffer_load_dword v15, v41, s[60:63], 0 offen sc1
  s_lshl_b32 s96, s101, 7
  s_mul_i32 s97, s101, 245760
  s_add_u32 m0, s94, 0
  s_add_u32 s101, s101, 1
  s_cmp_eq_u32 s101, 10
  s_cselect_b32 s101, 0, s101
  buffer_load_dwordx4 v24, s[32:35], s96 offen lds
  buffer_load_dwordx4 v25, s[32:35], s96 offen offset:1024 lds
  s_waitcnt lgkmcnt(3)
  v_mfma_f32_16x16x32_bf16 v[204:207], v[140:143], v[140:143], v[204:207]
  buffer_load_dwordx4 v26, s[32:35], s96 offen offset:2048 lds
  v_mfma_f32_16x16x32_bf16 v[212:215], v[4:7], v[140:143], v[212:215]
  buffer_load_dwordx4 v27, s[32:35], s96 offen offset:3072 lds
  s_add_u32 m0, s95, 16384
  s_waitcnt lgkmcnt(2)
  v_mfma_f32_16x16x32_bf16 v[208:211], v[144:147], v[144:147], v[208:211]
  buffer_load_dwordx4 v28, s[36:39], s97 offen offset:0 lds
  v_mfma_f32_16x16x32_bf16 v[216:219], v[4:7], v[144:147], v[216:219]
  buffer_load_dwordx4 v29, s[36:39], s97 offen offset:1024 lds
  s_add_u32 m0, s95, 24576
  s_waitcnt lgkmcnt(1)
  v_mfma_f32_16x16x32_bf16 v[204:207], v[148:151], v[148:151], v[204:207]
  buffer_load_dwordx4 v30, s[36:39], s97 offen offset:0 lds
  v_mfma_f32_16x16x32_bf16 v[212:215], v[4:7], v[148:151], v[212:215]
  buffer_load_dwordx4 v31, s[36:39], s97 offen offset:1024 lds
  s_waitcnt lgkmcnt(0)
  v_mfma_f32_16x16x32_bf16 v[208:211], v[152:155], v[152:155], v[208:211]
  v_mfma_f32_16x16x32_bf16 v[216:219], v[4:7], v[152:155], v[216:219]
  s_waitcnt vmcnt(9)
  s_barrier
  ds_read_b128 v[156:159], v10 offset:32768
  ds_read_b128 v[160:163], v10 offset:34816
  ds_read_b128 v[164:167], v11 offset:32768
  ds_read_b128 v[168:171], v11 offset:34816
  s_lshl_b32 s96, s101, 7
  s_mul_i32 s97, s101, 245760
  s_add_u32 m0, s94, 32768
  s_add_u32 s101, s101, 1
  s_cmp_eq_u32 s101, 10
  s_cselect_b32 s101, 0, s101
  buffer_load_dwordx4 v24, s[32:35], s96 offen lds
  buffer_load_dwordx4 v25, s[32:35], s96 offen offset:1024 lds
  s_waitcnt lgkmcnt(3)
  v_mfma_f32_16x16x32_bf16 v[204:207], v[156:159], v[156:159], v[204:207]
  buffer_load_dwordx4 v26, s[32:35], s96 offen offset:2048 lds
  v_mfma_f32_16x16x32_bf16 v[212:215], v[4:7], v[156:159], v[212:215]
  buffer_load_dwordx4 v27, s[32:35], s96 offen offset:3072 lds
  s_add_u32 m0, s95, 49152
  s_waitcnt lgkmcnt(2)
  v_mfma_f32_16x16x32_bf16 v[208:211], v[160:163], v[160:163], v[208:211]
  buffer_load_dwordx4 v28, s[36:39], s97 offen offset:0 lds
  v_mfma_f32_16x16x32_bf16 v[216:219], v[4:7], v[160:163], v[216:219]
  buffer_load_dwordx4 v29, s[36:39], s97 offen offset:1024 lds
  s_add_u32 m0, s95, 57344
  s_waitcnt lgkmcnt(1)
  v_mfma_f32_16x16x32_bf16 v[204:207], v[164:167], v[164:167], v[204:207]
  buffer_load_dwordx4 v30, s[36:39], s97 offen offset:0 lds
  v_mfma_f32_16x16x32_bf16 v[212:215], v[4:7], v[164:167], v[212:215]
  buffer_load_dwordx4 v31, s[36:39], s97 offen offset:1024 lds
  s_waitcnt lgkmcnt(0)
  v_mfma_f32_16x16x32_bf16 v[208:211], v[168:171], v[168:171], v[208:211]
  v_mfma_f32_16x16x32_bf16 v[216:219], v[4:7], v[168:171], v[216:219]
  s_mul_i32 s97, s101, 245760
  s_add_u32 m0, s95, 131072
  s_add_u32 s101, s101, 1
  s_cmp_eq_u32 s101, 10
  s_cselect_b32 s101, 0, s101
  buffer_load_dwordx4 v32, s[36:39], s97 offen lds
  buffer_load_dwordx4 v33, s[36:39], s97 offen offset:1024 lds
  s_mul_i32 s97, s101, 245760
  s_add_u32 m0, s95, 139264
  s_add_u32 s101, s101, 1
  s_cmp_eq_u32 s101, 10
  s_cselect_b32 s101, 0, s101
  buffer_load_dwordx4 v32, s[36:39], s97 offen lds
  buffer_load_dwordx4 v33, s[36:39], s97 offen offset:1024 lds
  s_mul_i32 s97, s101, 245760
  s_add_u32 m0, s95, 147456
  s_add_u32 s101, s101, 1
  s_cmp_eq_u32 s101, 10
  s_cselect_b32 s101, 0, s101
  buffer_load_dwordx4 v32, s[36:39], s97 offen lds
  buffer_load_dwordx4 v33, s[36:39], s97 offen offset:1024 lds
  s_waitcnt vmcnt(14)
  s_barrier
  ds_read_b128 v[172:175], v8 offset:0
  ds_read_b128 v[176:179], v8 offset:2048
  ds_read_b128 v[180:183], v9 offset:0
  ds_read_b128 v[184:187], v9 offset:2048
  s_waitcnt lgkmcnt(3)
  v_mfma_f32_16x16x32_bf16 v[204:207], v[172:175], v[172:175], v[204:207]
  v_mfma_f32_16x16x32_bf16 v[212:215], v[4:7], v[172:175], v[212:215]
  s_waitcnt lgkmcnt(2)
  v_mfma_f32_16x16x32_bf16 v[208:211], v[176:179], v[176:179], v[208:211]
  v_mfma_f32_16x16x32_bf16 v[216:219], v[4:7], v[176:179], v[216:219]
  s_waitcnt lgkmcnt(1)
  v_mfma_f32_16x16x32_bf16 v[204:207], v[180:183], v[180:183], v[204:207]
  v_mfma_f32_16x16x32_bf16 v[212:215], v[4:7], v[180:183], v[212:215]
  s_waitcnt lgkmcnt(0)
  v_mfma_f32_16x16x32_bf16 v[208:211], v[184:187], v[184:187], v[208:211]
  v_mfma_f32_16x16x32_bf16 v[216:219], v[4:7], v[184:187], v[216:219]
  s_waitcnt vmcnt(6)
  s_barrier
  ds_read_b128 v[188:191], v8 offset:32768
  ds_read_b128 v[192:195], v8 offset:34816
  ds_read_b128 v[196:199], v9 offset:32768
  ds_read_b128 v[200:203], v9 offset:34816
  s_waitcnt lgkmcnt(3)
  v_mfma_f32_16x16x32_bf16 v[204:207], v[188:191], v[188:191], v[204:207]
  v_mfma_f32_16x16x32_bf16 v[212:215], v[4:7], v[188:191], v[212:215]
  s_waitcnt lgkmcnt(2)
  v_mfma_f32_16x16x32_bf16 v[208:211], v[192:195], v[192:195], v[208:211]
  v_mfma_f32_16x16x32_bf16 v[216:219], v[4:7], v[192:195], v[216:219]
  s_waitcnt lgkmcnt(1)
  v_mfma_f32_16x16x32_bf16 v[204:207], v[196:199], v[196:199], v[204:207]
  v_mfma_f32_16x16x32_bf16 v[212:215], v[4:7], v[196:199], v[212:215]
  s_waitcnt lgkmcnt(0)
  v_mfma_f32_16x16x32_bf16 v[208:211], v[200:203], v[200:203], v[208:211]
  v_mfma_f32_16x16x32_bf16 v[216:219], v[4:7], v[200:203], v[216:219]
  s_mov_b32 s76, 0x3acccccd
  s_mov_b32 s77, 0x3727c5ac
  s_nop 1
  v_cndmask_b32 v17, v204, v205, s[90:91]
  s_nop 1
  v_cndmask_b32 v21, v208, v209, s[90:91]
  v_cndmask_b32 v17, v17, v206, s[92:93]
  v_cndmask_b32 v21, v21, v210, s[92:93]
  v_cndmask_b32 v17, v17, v207, s[74:75]
  v_cndmask_b32 v21, v21, v211, s[74:75]
  v_mul_f32 v212, s76, v212
  v_mul_f32 v216, s76, v216
  v_mul_f32 v17, s76, v17
  v_mul_f32 v21, s76, v21
  v_fma_f32 v17, -v212, v212, v17
  v_fma_f32 v21, -v216, v216, v21
  v_max_f32 v17, 0, v17
  v_max_f32 v21, 0, v21
  v_add_f32 v17, s77, v17
  v_add_f32 v21, s77, v21
  v_rsq_f32 v18, v17
  v_rsq_f32 v22, v21
  v_mul_f32 v19, -v212, v18
  v_mul_f32 v23, -v216, v22
  s_mov_b64 exec, s[72:73]
  ds_write2_b32 v40, v18, v19 offset0:0 offset1:128
  ds_write2_b32 v40, v22, v23 offset0:16 offset1:144
  s_mov_b64 exec, -1
  v_readfirstlane_b32 s76, v15
  s_nop 0
  s_cmp_ge_u32 s76, 84
  s_cbranch_scc1 L_zok
  s_mov_b32 s77, 0x400000
L_zpoll:
  buffer_load_dword v15, v41, s[60:63], 0 offen sc1
  s_waitcnt vmcnt(0)
  v_readfirstlane_b32 s76, v15
  s_sub_u32 s77, s77, 1
  s_cmp_eq_u32 s77, 0
  s_cbranch_scc1 L_zok
  s_cmp_lt_u32 s76, 84
  s_cbranch_scc1 L_zpoll
L_zok:
  s_mul_i32 s97, s101, 245760
  s_add_u32 m0, s95, 65536
  s_add_u32 s101, s101, 1
  s_cmp_eq_u32 s101, 10
  s_cselect_b32 s101, 0, s101
  buffer_load_dwordx4 v32, s[36:39], s97 offen lds
  buffer_load_dwordx4 v33, s[36:39], s97 offen offset:1024 lds
  s_mul_i32 s97, s101, 245760
  s_add_u32 m0, s95, 73728
  s_add_u32 s101, s101, 1
  s_cmp_eq_u32 s101, 10
  s_cselect_b32 s101, 0, s101
  buffer_load_dwordx4 v32, s[36:39], s97 offen lds
  buffer_load_dwordx4 v33, s[36:39], s97 offen offset:1024 lds
  s_waitcnt lgkmcnt(0)
  s_barrier
  ds_read2_b32 v[24:25], v40 offset0:0 offset1:128
  ds_read2_b32 v[26:27], v40 offset0:16 offset1:144
  s_mul_i32 s97, s101, 245760
  s_add_u32 m0, s95, 81920
  s_add_u32 s101, s101, 1
  s_cmp_eq_u32 s101, 10
  s_cselect_b32 s101, 0, s101
  buffer_load_dwordx4 v32, s[36:39], s97 offen lds
  buffer_load_dwordx4 v33, s[36:39], s97 offen offset:1024 lds
  s_mul_i32 s97, s101, 245760
  s_add_u32 m0, s95, 90112
  s_add_u32 s101, s101, 1
  s_cmp_eq_u32 s101, 10
  s_cselect_b32 s101, 0, s101
  buffer_load_dwordx4 v32, s[36:39], s97 offen lds
  buffer_load_dwordx4 v33, s[36:39], s97 offen offset:1024 lds
  s_mul_i32 s97, s101, 245760
  s_add_u32 m0, s95, 98304
  s_add_u32 s101, s101, 1
  s_cmp_eq_u32 s101, 10
  s_cselect_b32 s101, 0, s101
  buffer_load_dwordx4 v32, s[36:39], s97 offen lds
  buffer_load_dwordx4 v33, s[36:39], s97 offen offset:1024 lds
  s_mul_i32 s97, s101, 245760
  s_add_u32 m0, s95, 106496
  s_add_u32 s101, s101, 1
  s_cmp_eq_u32 s101, 10
  s_cselect_b32 s101, 0, s101
  buffer_load_dwordx4 v32, s[36:39], s97 offen lds
  buffer_load_dwordx4 v33, s[36:39], s97 offen offset:1024 lds
  s_mul_i32 s97, s101, 245760
  s_add_u32 m0, s95, 114688
  s_add_u32 s101, s101, 1
  s_cmp_eq_u32 s101, 10
  s_cselect_b32 s101, 0, s101
  buffer_load_dwordx4 v32, s[36:39], s97 offen lds
  buffer_load_dwordx4 v33, s[36:39], s97 offen offset:1024 lds
  v_min_u32 v16, 31, v1
  v_mul_lo_u32 v16, v16, s100
  buffer_load_dword v14, v16, s[48:51], s11 offen nt
  s_waitcnt vmcnt(15)
  s_mov_b64 exec, 1
  ds_add_u32 v12, v13 offset:0
  s_mov_b64 exec, -1
  s_waitcnt lgkmcnt(0)
  s_mov_b32 s0, 0x1000000
L_lwq0:
  ds_read_b32 v15, v12 offset:0
  s_sub_u32 s0, s0, 1
  s_cselect_b32 s1, 0, 4
  s_waitcnt lgkmcnt(0)
  v_readfirstlane_b32 s79, v15
  s_nop 0
  s_cmp_lt_u32 s79, s1
  s_cbranch_scc1 L_lwq0
  ds_read_b64_tr_b16 v[240:241], v37 offset:0
  ds_read_b64_tr_b16 v[242:243], v37 offset:512
  ds_read_b64_tr_b16 v[244:245], v38 offset:0
  ds_read_b64_tr_b16 v[246:247], v38 offset:512
  ds_read_b64_tr_b16 v[248:249], v39 offset:0
  ds_read_b64_tr_b16 v[250:251], v39 offset:512
  s_waitcnt lgkmcnt(4)
  v_mfma_f32_16x16x32_bf16 v[204:207], v[240:243], v[44:47], 0
  ds_read_b64_tr_b16 v[16:17], v37 offset:4096
  v_mfma_f32_16x16x32_bf16 v[208:211], v[240:243], v[48:51], 0
  ds_read_b64_tr_b16 v[18:19], v37 offset:4608
  v_mfma_f32_16x16x32_bf16 v[228:231], v[240:243], v[4:7], 0
  ds_read_b64_tr_b16 v[20:21], v38 offset:4096
  s_waitcnt lgkmcnt(5)
  v_mfma_f32_16x16x32_bf16 v[212:215], v[244:247], v[44:47], 0
  ds_read_b64_tr_b16 v[22:23], v38 offset:4608
  v_mfma_f32_16x16x32_bf16 v[216:219], v[244:247], v[48:51], 0
  ds_read_b64_tr_b16 v[28:29], v39 offset:4096
  v_mfma_f32_16x16x32_bf16 v[232:235], v[244:247], v[4:7], 0
  ds_read_b64_tr_b16 v[30:31], v39 offset:4608
  s_waitcnt lgkmcnt(6)
  v_mfma_f32_16x16x32_bf16 v[220:223], v[248:251], v[44:47], 0
  v_mfma_f32_16x16x32_bf16 v[224:227], v[248:251], v[48:51], 0
  v_mfma_f32_16x16x32_bf16 v[236:239], v[248:251], v[4:7], 0
  s_waitcnt lgkmcnt(4)
  v_mfma_f32_16x16x32_bf16 v[204:207], v[16:19], v[52:55], v[204:207]
  ds_read_b64_tr_b16 v[240:241], v37 offset:8192
  v_mfma_f32_16x16x32_bf16 v[208:211], v[16:19], v[56:59], v[208:211]
  ds_read_b64_tr_b16 v[242:243], v37 offset:8704
  v_mfma_f32_16x16x32_bf16 v[228:231], v[16:19], v[4:7], v[228:231]
  ds_read_b64_tr_b16 v[244:245], v38 offset:8192
  s_waitcnt lgkmcnt(5)
  v_mfma_f32_16x16x32_bf16 v[212:215], v[20:23], v[52:55], v[212:215]
  ds_read_b64_tr_b16 v[246:247], v38 offset:8704
  v_mfma_f32_16x16x32_bf16 v[216:219], v[20:23], v[56:59], v[216:219]
  ds_read_b64_tr_b16 v[248:249], v39 offset:8192
  v_mfma_f32_16x16x32_bf16 v[232:235], v[20:23], v[4:7], v[232:235]
  ds_read_b64_tr_b16 v[250:251], v39 offset:8704
  s_waitcnt lgkmcnt(6)
  v_mfma_f32_16x16x32_bf16 v[220:223], v[28:31], v[52:55], v[220:223]
  v_mfma_f32_16x16x32_bf16 v[224:227], v[28:31], v[56:59], v[224:227]
  v_mfma_f32_16x16x32_bf16 v[236:239], v[28:31], v[4:7], v[236:239]
  s_waitcnt lgkmcnt(4)
  v_mfma_f32_16x16x32_bf16 v[204:207], v[240:243], v[60:63], v[204:207]
  ds_read_b64_tr_b16 v[16:17], v37 offset:12288
  v_mfma_f32_16x16x32_bf16 v[208:211], v[240:243], v[64:67], v[208:211]
  ds_read_b64_tr_b16 v[18:19], v37 offset:12800
  v_mfma_f32_16x16x32_bf16 v[228:231], v[240:243], v[4:7], v[228:231]
  ds_read_b64_tr_b16 v[20:21], v38 offset:12288
  s_waitcnt lgkmcnt(5)
  v_mfma_f32_16x16x32_bf16 v[212:215], v[244:247], v[60:63], v[212:215]
  ds_read_b64_tr_b16 v[22:23], v38 offset:12800
  v_mfma_f32_16x16x32_bf16 v[216:219], v[244:247], v[64:67], v[216:219]
  ds_read_b64_tr_b16 v[28:29], v39 offset:12288
  v_mfma_f32_16x16x32_bf16 v[232:235], v[244:247], v[4:7], v[232:235]
  ds_read_b64_tr_b16 v[30:31], v39 offset:12800
  s_waitcnt lgkmcnt(6)
  v_mfma_f32_16x16x32_bf16 v[220:223], v[248:251], v[60:63], v[220:223]
  v_mfma_f32_16x16x32_bf16 v[224:227], v[248:251], v[64:67], v[224:227]
  v_mfma_f32_16x16x32_bf16 v[236:239], v[248:251], v[4:7], v[236:239]
  s_waitcnt lgkmcnt(4)
  v_mfma_f32_16x16x32_bf16 v[204:207], v[16:19], v[68:71], v[204:207]
  ds_read_b64_tr_b16 v[240:241], v37 offset:16384
  v_mfma_f32_16x16x32_bf16 v[208:211], v[16:19], v[72:75], v[208:211]
  ds_read_b64_tr_b16 v[242:243], v37 offset:16896
  v_mfma_f32_16x16x32_bf16 v[228:231], v[16:19], v[4:7], v[228:231]
  ds_read_b64_tr_b16 v[244:245], v38 offset:16384
  s_waitcnt lgkmcnt(5)
  v_mfma_f32_16x16x32_bf16 v[212:215], v[20:23], v[68:71], v[212:215]
  ds_read_b64_tr_b16 v[246:247], v38 offset:16896
  v_mfma_f32_16x16x32_bf16 v[216:219], v[20:23], v[72:75], v[216:219]
  ds_read_b64_tr_b16 v[248:249], v39 offset:16384
  v_mfma_f32_16x16x32_bf16 v[232:235], v[20:23], v[4:7], v[232:235]
  ds_read_b64_tr_b16 v[250:251], v39 offset:16896
  s_waitcnt lgkmcnt(6)
  v_mfma_f32_16x16x32_bf16 v[220:223], v[28:31], v[68:71], v[220:223]
  v_mfma_f32_16x16x32_bf16 v[224:227], v[28:31], v[72:75], v[224:227]
  v_mfma_f32_16x16x32_bf16 v[236:239], v[28:31], v[4:7], v[236:239]
  s_waitcnt lgkmcnt(4)
  v_mfma_f32_16x16x32_bf16 v[204:207], v[240:243], v[76:79], v[204:207]
  ds_read_b64_tr_b16 v[16:17], v37 offset:20480
  v_mfma_f32_16x16x32_bf16 v[208:211], v[240:243], v[80:83], v[208:211]
  ds_read_b64_tr_b16 v[18:19], v37 offset:20992
  v_mfma_f32_16x16x32_bf16 v[228:231], v[240:243], v[4:7], v[228:231]
  ds_read_b64_tr_b16 v[20:21], v38 offset:20480
  s_waitcnt lgkmcnt(5)
  v_mfma_f32_16x16x32_bf16 v[212:215], v[244:247], v[76:79], v[212:215]
  ds_read_b64_tr_b16 v[22:23], v38 offset:20992
  v_mfma_f32_16x16x32_bf16 v[216:219], v[244:247], v[80:83], v[216:219]
  ds_read_b64_tr_b16 v[28:29], v39 offset:20480
  v_mfma_f32_16x16x32_bf16 v[232:235], v[244:247], v[4:7], v[232:235]
  ds_read_b64_tr_b16 v[30:31], v39 offset:20992
  s_waitcnt lgkmcnt(6)
  v_mfma_f32_16x16x32_bf16 v[220:223], v[248:251], v[76:79], v[220:223]
  v_mfma_f32_16x16x32_bf16 v[224:227], v[248:251], v[80:83], v[224:227]
  v_mfma_f32_16x16x32_bf16 v[236:239], v[248:251], v[4:7], v[236:239]
  s_waitcnt lgkmcnt(4)
  v_mfma_f32_16x16x32_bf16 v[204:207], v[16:19], v[84:87], v[204:207]
  v_mfma_f32_16x16x32_bf16 v[208:211], v[16:19], v[88:91], v[208:211]
  s_waitcnt vmcnt(7)
  s_mov_b64 exec, 1
  ds_add_u32 v12, v13 offset:4
  s_mov_b64 exec, -1
  s_waitcnt lgkmcnt(0)
  s_mov_b32 s0, 0x1000000
L_lwq6:
  ds_read_b32 v15, v12 offset:4
  s_sub_u32 s0, s0, 1
  s_cselect_b32 s1, 0, 4
  s_waitcnt lgkmcnt(0)
  v_readfirstlane_b32 s79, v15
  s_nop 0
  s_cmp_lt_u32 s79, s1
  s_cbranch_scc1 L_lwq6
  v_mfma_f32_16x16x32_bf16 v[228:231], v[16:19], v[4:7], v[228:231]
  ds_read_b64_tr_b16 v[240:241], v34 offset:0
  ds_read_b64_tr_b16 v[242:243], v34 offset:512
  v_mfma_f32_16x16x32_bf16 v[212:215], v[20:23], v[84:87], v[212:215]
  ds_read_b64_tr_b16 v[244:245], v35 offset:0
  ds_read_b64_tr_b16 v[246:247], v35 offset:512
  v_mfma_f32_16x16x32_bf16 v[216:219], v[20:23], v[88:91], v[216:219]
  ds_read_b64_tr_b16 v[248:249], v36 offset:0
  ds_read_b64_tr_b16 v[250:251], v36 offset:512
  v_mfma_f32_16x16x32_bf16 v[232:235], v[20:23], v[4:7], v[232:235]
  v_mfma_f32_16x16x32_bf16 v[220:223], v[28:31], v[84:87], v[220:223]
  v_mfma_f32_16x16x32_bf16 v[224:227], v[28:31], v[88:91], v[224:227]
  v_mfma_f32_16x16x32_bf16 v[236:239], v[28:31], v[4:7], v[236:239]
  s_waitcnt lgkmcnt(4)
  v_mfma_f32_16x16x32_bf16 v[204:207], v[240:243], v[92:95], v[204:207]
  ds_read_b64_tr_b16 v[16:17], v34 offset:4096
  v_mfma_f32_16x16x32_bf16 v[208:211], v[240:243], v[96:99], v[208:211]
  ds_read_b64_tr_b16 v[18:19], v34 offset:4608
  v_mfma_f32_16x16x32_bf16 v[228:231], v[240:243], v[4:7], v[228:231]
  ds_read_b64_tr_b16 v[20:21], v35 offset:4096
  s_waitcnt lgkmcnt(5)
  v_mfma_f32_16x16x32_bf16 v[212:215], v[244:247], v[92:95], v[212:215]
  ds_read_b64_tr_b16 v[22:23], v35 offset:4608
  v_mfma_f32_16x16x32_bf16 v[216:219], v[244:247], v[96:99], v[216:219]
  ds_read_b64_tr_b16 v[28:29], v36 offset:4096
  v_mfma_f32_16x16x32_bf16 v[232:235], v[244:247], v[4:7], v[232:235]
  ds_read_b64_tr_b16 v[30:31], v36 offset:4608
  s_waitcnt lgkmcnt(6)
  v_mfma_f32_16x16x32_bf16 v[220:223], v[248:251], v[92:95], v[220:223]
  v_mfma_f32_16x16x32_bf16 v[224:227], v[248:251], v[96:99], v[224:227]
  v_mfma_f32_16x16x32_bf16 v[236:239], v[248:251], v[4:7], v[236:239]
  s_waitcnt lgkmcnt(4)
  v_mfma_f32_16x16x32_bf16 v[204:207], v[16:19], v[100:103], v[204:207]
  ds_read_b64_tr_b16 v[240:241], v34 offset:8192
  v_mfma_f32_16x16x32_bf16 v[208:211], v[16:19], v[104:107], v[208:211]
  ds_read_b64_tr_b16 v[242:243], v34 offset:8704
  v_mfma_f32_16x16x32_bf16 v[228:231], v[16:19], v[4:7], v[228:231]
  ds_read_b64_tr_b16 v[244:245], v35 offset:8192
  s_waitcnt lgkmcnt(5)
  v_mfma_f32_16x16x32_bf16 v[212:215], v[20:23], v[100:103], v[212:215]
  ds_read_b64_tr_b16 v[246:247], v35 offset:8704
  v_mfma_f32_16x16x32_bf16 v[216:219], v[20:23], v[104:107], v[216:219]
  ds_read_b64_tr_b16 v[248:249], v36 offset:8192
  v_mfma_f32_16x16x32_bf16 v[232:235], v[20:23], v[4:7], v[232:235]
  ds_read_b64_tr_b16 v[250:251], v36 offset:8704
  s_waitcnt lgkmcnt(6)
  v_mfma_f32_16x16x32_bf16 v[220:223], v[28:31], v[100:103], v[220:223]
  v_mfma_f32_16x16x32_bf16 v[224:227], v[28:31], v[104:107], v[224:227]
  v_mfma_f32_16x16x32_bf16 v[236:239], v[28:31], v[4:7], v[236:239]
  s_waitcnt lgkmcnt(4)
  v_mfma_f32_16x16x32_bf16 v[204:207], v[240:243], v[108:111], v[204:207]
  ds_read_b64_tr_b16 v[16:17], v34 offset:12288
  v_mfma_f32_16x16x32_bf16 v[208:211], v[240:243], v[112:115], v[208:211]
  ds_read_b64_tr_b16 v[18:19], v34 offset:12800
  v_mfma_f32_16x16x32_bf16 v[228:231], v[240:243], v[4:7], v[228:231]
  ds_read_b64_tr_b16 v[20:21], v35 offset:12288
  s_waitcnt lgkmcnt(5)
  v_mfma_f32_16x16x32_bf16 v[212:215], v[244:247], v[108:111], v[212:215]
  ds_read_b64_tr_b16 v[22:23], v35 offset:12800
  v_mfma_f32_16x16x32_bf16 v[216:219], v[244:247], v[112:115], v[216:219]
  ds_read_b64_tr_b16 v[28:29], v36 offset:12288
  v_mfma_f32_16x16x32_bf16 v[232:235], v[244:247], v[4:7], v[232:235]
  ds_read_b64_tr_b16 v[30:31], v36 offset:12800
  s_waitcnt lgkmcnt(6)
  v_mfma_f32_16x16x32_bf16 v[220:223], v[248:251], v[108:111], v[220:223]
  v_mfma_f32_16x16x32_bf16 v[224:227], v[248:251], v[112:115], v[224:227]
  v_mfma_f32_16x16x32_bf16 v[236:239], v[248:251], v[4:7], v[236:239]
  s_waitcnt lgkmcnt(4)
  v_mfma_f32_16x16x32_bf16 v[204:207], v[16:19], v[116:119], v[204:207]
  ds_read_b64_tr_b16 v[240:241], v34 offset:16384
  v_mfma_f32_16x16x32_bf16 v[208:211], v[16:19], v[120:123], v[208:211]
  ds_read_b64_tr_b16 v[242:243], v34 offset:16896
  v_mfma_f32_16x16x32_bf16 v[228:231], v[16:19], v[4:7], v[228:231]
  ds_read_b64_tr_b16 v[244:245], v35 offset:16384
  s_waitcnt lgkmcnt(5)
  v_mfma_f32_16x16x32_bf16 v[212:215], v[20:23], v[116:119], v[212:215]
  ds_read_b64_tr_b16 v[246:247], v35 offset:16896
  v_mfma_f32_16x16x32_bf16 v[216:219], v[20:23], v[120:123], v[216:219]
  ds_read_b64_tr_b16 v[248:249], v36 offset:16384
  v_mfma_f32_16x16x32_bf16 v[232:235], v[20:23], v[4:7], v[232:235]
  ds_read_b64_tr_b16 v[250:251], v36 offset:16896
  s_waitcnt lgkmcnt(6)
  v_mfma_f32_16x16x32_bf16 v[220:223], v[28:31], v[116:119], v[220:223]
  v_mfma_f32_16x16x32_bf16 v[224:227], v[28:31], v[120:123], v[224:227]
  v_mfma_f32_16x16x32_bf16 v[236:239], v[28:31], v[4:7], v[236:239]
  s_waitcnt lgkmcnt(4)
  v_mfma_f32_16x16x32_bf16 v[204:207], v[240:243], v[124:127], v[204:207]
  ds_read_b64_tr_b16 v[16:17], v34 offset:20480
  v_mfma_f32_16x16x32_bf16 v[208:211], v[240:243], v[128:131], v[208:211]
  ds_read_b64_tr_b16 v[18:19], v34 offset:20992
  v_mfma_f32_16x16x32_bf16 v[228:231], v[240:243], v[4:7], v[228:231]
  ds_read_b64_tr_b16 v[20:21], v35 offset:20480
  s_waitcnt lgkmcnt(5)
  v_mfma_f32_16x16x32_bf16 v[212:215], v[244:247], v[124:127], v[212:215]
  ds_read_b64_tr_b16 v[22:23], v35 offset:20992
  v_mfma_f32_16x16x32_bf16 v[216:219], v[244:247], v[128:131], v[216:219]
  ds_read_b64_tr_b16 v[28:29], v36 offset:20480
  v_mfma_f32_16x16x32_bf16 v[232:235], v[244:247], v[4:7], v[232:235]
  ds_read_b64_tr_b16 v[30:31], v36 offset:20992
  s_waitcnt lgkmcnt(6)
  v_mfma_f32_16x16x32_bf16 v[220:223], v[248:251], v[124:127], v[220:223]
  v_mfma_f32_16x16x32_bf16 v[224:227], v[248:251], v[128:131], v[224:227]
  v_mfma_f32_16x16x32_bf16 v[236:239], v[248:251], v[4:7], v[236:239]
  s_waitcnt lgkmcnt(4)
  v_mfma_f32_16x16x32_bf16 v[204:207], v[16:19], v[132:135], v[204:207]
  ds_read_b64_tr_b16 v[240:241], v34 offset:24576
  v_mfma_f32_16x16x32_bf16 v[208:211], v[16:19], v[136:139], v[208:211]
  ds_read_b64_tr_b16 v[242:243], v34 offset:25088
  v_mfma_f32_16x16x32_bf16 v[228:231], v[16:19], v[4:7], v[228:231]
  ds_read_b64_tr_b16 v[244:245], v35 offset:24576
  s_waitcnt lgkmcnt(5)
  v_mfma_f32_16x16x32_bf16 v[212:215], v[20:23], v[132:135], v[212:215]
  ds_read_b64_tr_b16 v[246:247], v35 offset:25088
  v_mfma_f32_16x16x32_bf16 v[216:219], v[20:23], v[136:139], v[216:219]
  ds_read_b64_tr_b16 v[248:249], v36 offset:24576
  v_mfma_f32_16x16x32_bf16 v[232:235], v[20:23], v[4:7], v[232:235]
  ds_read_b64_tr_b16 v[250:251], v36 offset:25088
  s_waitcnt lgkmcnt(6)
  v_mfma_f32_16x16x32_bf16 v[220:223], v[28:31], v[132:135], v[220:223]
  v_mfma_f32_16x16x32_bf16 v[224:227], v[28:31], v[136:139], v[224:227]
  v_mfma_f32_16x16x32_bf16 v[236:239], v[28:31], v[4:7], v[236:239]
  s_waitcnt lgkmcnt(4)
  v_mfma_f32_16x16x32_bf16 v[204:207], v[240:243], v[140:143], v[204:207]
  ds_read_b64_tr_b16 v[16:17], v34 offset:28672
  v_mfma_f32_16x16x32_bf16 v[208:211], v[240:243], v[144:147], v[208:211]
  ds_read_b64_tr_b16 v[18:19], v34 offset:29184
  v_mfma_f32_16x16x32_bf16 v[228:231], v[240:243], v[4:7], v[228:231]
  ds_read_b64_tr_b16 v[20:21], v35 offset:28672
  s_waitcnt lgkmcnt(5)
  v_mfma_f32_16x16x32_bf16 v[212:215], v[244:247], v[140:143], v[212:215]
  ds_read_b64_tr_b16 v[22:23], v35 offset:29184
  v_mfma_f32_16x16x32_bf16 v[216:219], v[244:247], v[144:147], v[216:219]
  ds_read_b64_tr_b16 v[28:29], v36 offset:28672
  v_mfma_f32_16x16x32_bf16 v[232:235], v[244:247], v[4:7], v[232:235]
  ds_read_b64_tr_b16 v[30:31], v36 offset:29184
  s_waitcnt lgkmcnt(6)
  v_mfma_f32_16x16x32_bf16 v[220:223], v[248:251], v[140:143], v[220:223]
  v_mfma_f32_16x16x32_bf16 v[224:227], v[248:251], v[144:147], v[224:227]
  v_mfma_f32_16x16x32_bf16 v[236:239], v[248:251], v[4:7], v[236:239]
  s_waitcnt lgkmcnt(4)
  v_mfma_f32_16x16x32_bf16 v[204:207], v[16:19], v[148:151], v[204:207]
  v_mfma_f32_16x16x32_bf16 v[208:211], v[16:19], v[152:155], v[208:211]
  s_waitcnt vmcnt(1)
  s_mov_b64 exec, 1
  ds_add_u32 v12, v13 offset:8
  s_mov_b64 exec, -1
  s_waitcnt lgkmcnt(0)
  s_mov_b32 s0, 0x1000000
L_lwq14:
  ds_read_b32 v15, v12 offset:8
  s_sub_u32 s0, s0, 1
  s_cselect_b32 s1, 0, 4
  s_waitcnt lgkmcnt(0)
  v_readfirstlane_b32 s79, v15
  s_nop 0
  s_cmp_lt_u32 s79, s1
  s_cbranch_scc1 L_lwq14
  v_mfma_f32_16x16x32_bf16 v[228:231], v[16:19], v[4:7], v[228:231]
  ds_read_b64_tr_b16 v[240:241], v34 offset:32768
  ds_read_b64_tr_b16 v[242:243], v34 offset:33280
  v_mfma_f32_16x16x32_bf16 v[212:215], v[20:23], v[148:151], v[212:215]
  ds_read_b64_tr_b16 v[244:245], v35 offset:32768
  ds_read_b64_tr_b16 v[246:247], v35 offset:33280
  v_mfma_f32_16x16x32_bf16 v[216:219], v[20:23], v[152:155], v[216:219]
  ds_read_b64_tr_b16 v[248:249], v36 offset:32768
  ds_read_b64_tr_b16 v[250:251], v36 offset:33280
  v_mfma_f32_16x16x32_bf16 v[232:235], v[20:23], v[4:7], v[232:235]
  v_mfma_f32_16x16x32_bf16 v[220:223], v[28:31], v[148:151], v[220:223]
  v_mfma_f32_16x16x32_bf16 v[224:227], v[28:31], v[152:155], v[224:227]
  v_mfma_f32_16x16x32_bf16 v[236:239], v[28:31], v[4:7], v[236:239]
  s_waitcnt lgkmcnt(4)
  v_mfma_f32_16x16x32_bf16 v[204:207], v[240:243], v[156:159], v[204:207]
  ds_read_b64_tr_b16 v[16:17], v34 offset:36864
  v_mfma_f32_16x16x32_bf16 v[208:211], v[240:243], v[160:163], v[208:211]
  ds_read_b64_tr_b16 v[18:19], v34 offset:37376
  v_mfma_f32_16x16x32_bf16 v[228:231], v[240:243], v[4:7], v[228:231]
  ds_read_b64_tr_b16 v[20:21], v35 offset:36864
  s_waitcnt lgkmcnt(5)
  v_mfma_f32_16x16x32_bf16 v[212:215], v[244:247], v[156:159], v[212:215]
  ds_read_b64_tr_b16 v[22:23], v35 offset:37376
  v_mfma_f32_16x16x32_bf16 v[216:219], v[244:247], v[160:163], v[216:219]
  ds_read_b64_tr_b16 v[28:29], v36 offset:36864
  v_mfma_f32_16x16x32_bf16 v[232:235], v[244:247], v[4:7], v[232:235]
  ds_read_b64_tr_b16 v[30:31], v36 offset:37376
  s_waitcnt lgkmcnt(6)
  v_mfma_f32_16x16x32_bf16 v[220:223], v[248:251], v[156:159], v[220:223]
  v_mfma_f32_16x16x32_bf16 v[224:227], v[248:251], v[160:163], v[224:227]
  v_mfma_f32_16x16x32_bf16 v[236:239], v[248:251], v[4:7], v[236:239]
  s_waitcnt lgkmcnt(4)
  v_mfma_f32_16x16x32_bf16 v[204:207], v[16:19], v[164:167], v[204:207]
  ds_read_b64_tr_b16 v[240:241], v34 offset:40960
  v_mfma_f32_16x16x32_bf16 v[208:211], v[16:19], v[168:171], v[208:211]
  ds_read_b64_tr_b16 v[242:243], v34 offset:41472
  v_mfma_f32_16x16x32_bf16 v[228:231], v[16:19], v[4:7], v[228:231]
  ds_read_b64_tr_b16 v[244:245], v35 offset:40960
  s_waitcnt lgkmcnt(5)
  v_mfma_f32_16x16x32_bf16 v[212:215], v[20:23], v[164:167], v[212:215]
  ds_read_b64_tr_b16 v[246:247], v35 offset:41472
  v_mfma_f32_16x16x32_bf16 v[216:219], v[20:23], v[168:171], v[216:219]
  ds_read_b64_tr_b16 v[248:249], v36 offset:40960
  v_mfma_f32_16x16x32_bf16 v[232:235], v[20:23], v[4:7], v[232:235]
  ds_read_b64_tr_b16 v[250:251], v36 offset:41472
  s_waitcnt lgkmcnt(6)
  v_mfma_f32_16x16x32_bf16 v[220:223], v[28:31], v[164:167], v[220:223]
  v_mfma_f32_16x16x32_bf16 v[224:227], v[28:31], v[168:171], v[224:227]
  v_mfma_f32_16x16x32_bf16 v[236:239], v[28:31], v[4:7], v[236:239]
  s_waitcnt lgkmcnt(4)
  v_mfma_f32_16x16x32_bf16 v[204:207], v[240:243], v[172:175], v[204:207]
  ds_read_b64_tr_b16 v[16:17], v34 offset:45056
  v_mfma_f32_16x16x32_bf16 v[208:211], v[240:243], v[176:179], v[208:211]
  ds_read_b64_tr_b16 v[18:19], v34 offset:45568
  v_mfma_f32_16x16x32_bf16 v[228:231], v[240:243], v[4:7], v[228:231]
  ds_read_b64_tr_b16 v[20:21], v35 offset:45056
  s_waitcnt lgkmcnt(5)
  v_mfma_f32_16x16x32_bf16 v[212:215], v[244:247], v[172:175], v[212:215]
  ds_read_b64_tr_b16 v[22:23], v35 offset:45568
  v_mfma_f32_16x16x32_bf16 v[216:219], v[244:247], v[176:179], v[216:219]
  ds_read_b64_tr_b16 v[28:29], v36 offset:45056
  v_mfma_f32_16x16x32_bf16 v[232:235], v[244:247], v[4:7], v[232:235]
  ds_read_b64_tr_b16 v[30:31], v36 offset:45568
  s_waitcnt lgkmcnt(6)
  v_mfma_f32_16x16x32_bf16 v[220:223], v[248:251], v[172:175], v[220:223]
  v_mfma_f32_16x16x32_bf16 v[224:227], v[248:251], v[176:179], v[224:227]
  v_mfma_f32_16x16x32_bf16 v[236:239], v[248:251], v[4:7], v[236:239]
  s_waitcnt lgkmcnt(4)
  v_mfma_f32_16x16x32_bf16 v[204:207], v[16:19], v[180:183], v[204:207]
  ds_read_b64_tr_b16 v[240:241], v34 offset:49152
  v_mfma_f32_16x16x32_bf16 v[208:211], v[16:19], v[184:187], v[208:211]
  ds_read_b64_tr_b16 v[242:243], v34 offset:49664
  v_mfma_f32_16x16x32_bf16 v[228:231], v[16:19], v[4:7], v[228:231]
  ds_read_b64_tr_b16 v[244:245], v35 offset:49152
  s_waitcnt lgkmcnt(5)
  v_mfma_f32_16x16x32_bf16 v[212:215], v[20:23], v[180:183], v[212:215]
  ds_read_b64_tr_b16 v[246:247], v35 offset:49664
  v_mfma_f32_16x16x32_bf16 v[216:219], v[20:23], v[184:187], v[216:219]
  ds_read_b64_tr_b16 v[248:249], v36 offset:49152
  v_mfma_f32_16x16x32_bf16 v[232:235], v[20:23], v[4:7], v[232:235]
  ds_read_b64_tr_b16 v[250:251], v36 offset:49664
  s_waitcnt lgkmcnt(6)
  v_mfma_f32_16x16x32_bf16 v[220:223], v[28:31], v[180:183], v[220:223]
  v_mfma_f32_16x16x32_bf16 v[224:227], v[28:31], v[184:187], v[224:227]
  v_mfma_f32_16x16x32_bf16 v[236:239], v[28:31], v[4:7], v[236:239]
  s_waitcnt lgkmcnt(4)
  v_mfma_f32_16x16x32_bf16 v[204:207], v[240:243], v[188:191], v[204:207]
  ds_read_b64_tr_b16 v[16:17], v34 offset:53248
  v_mfma_f32_16x16x32_bf16 v[208:211], v[240:243], v[192:195], v[208:211]
  ds_read_b64_tr_b16 v[18:19], v34 offset:53760
  v_mfma_f32_16x16x32_bf16 v[228:231], v[240:243], v[4:7], v[228:231]
  ds_read_b64_tr_b16 v[20:21], v35 offset:53248
  s_waitcnt lgkmcnt(5)
  v_mfma_f32_16x16x32_bf16 v[212:215], v[244:247], v[188:191], v[212:215]
  ds_read_b64_tr_b16 v[22:23], v35 offset:53760
  v_mfma_f32_16x16x32_bf16 v[216:219], v[244:247], v[192:195], v[216:219]
  ds_read_b64_tr_b16 v[28:29], v36 offset:53248
  v_mfma_f32_16x16x32_bf16 v[232:235], v[244:247], v[4:7], v[232:235]
  ds_read_b64_tr_b16 v[30:31], v36 offset:53760
  s_waitcnt lgkmcnt(6)
  v_mfma_f32_16x16x32_bf16 v[220:223], v[248:251], v[188:191], v[220:223]
  v_mfma_f32_16x16x32_bf16 v[224:227], v[248:251], v[192:195], v[224:227]
  v_mfma_f32_16x16x32_bf16 v[236:239], v[248:251], v[4:7], v[236:239]
  s_waitcnt lgkmcnt(4)
  v_mfma_f32_16x16x32_bf16 v[204:207], v[16:19], v[196:199], v[204:207]
  v_mfma_f32_16x16x32_bf16 v[208:211], v[16:19], v[200:203], v[208:211]
  v_mfma_f32_16x16x32_bf16 v[228:231], v[16:19], v[4:7], v[228:231]
  s_waitcnt lgkmcnt(2)
  v_mfma_f32_16x16x32_bf16 v[212:215], v[20:23], v[196:199], v[212:215]
  v_mfma_f32_16x16x32_bf16 v[216:219], v[20:23], v[200:203], v[216:219]
  v_mfma_f32_16x16x32_bf16 v[232:235], v[20:23], v[4:7], v[232:235]
  s_waitcnt lgkmcnt(0)
  v_mfma_f32_16x16x32_bf16 v[220:223], v[28:31], v[196:199], v[220:223]
  v_mfma_f32_16x16x32_bf16 v[224:227], v[28:31], v[200:203], v[224:227]
  v_mfma_f32_16x16x32_bf16 v[236:239], v[28:31], v[4:7], v[236:239]
  s_mov_b64 exec, 1
  ds_add_u32 v12, v13 offset:24
  s_mov_b64 exec, -1
  v_mov_b32 v44, 0x3fb8aa3b
  v_mov_b32 v46, 0xb5c1a2a0
  v_mov_b32 v48, 0x358637bd
  v_mov_b32 v156, 0x358637bd
  v_mov_b32 v157, 0x358637bd
  v_mov_b32 v158, 0
  v_mov_b32 v159, 0
  v_lshlrev_b32 v162, 2, v1
  s_xor_b32 s74, s28, 1
  s_lshl_b32 s72, s80, 1
  s_lshl_b32 s73, s27, 3
  s_add_u32 s72, s72, s73
  s_lshl_b32 s72, s72, 4
  s_add_u32 s72, s72, s74
  s_mul_i32 s72, s72, 1280
  s_add_u32 s72, s72, 1048576
  s_add_u32 s73, s72, 20480
  s_lshl_b32 s75, s74, 7
  s_add_u32 s75, s75, 65536
  s_lshl_b32 s74, s74, 12
  s_add_u32 s74, s74, 24117248
  s_mov_b32 s90, 0x0000ffff
  s_mov_b32 s91, 0x00000000
  s_mov_b32 s92, 0xffff0000
  s_mov_b32 s93, 0x00000000
  s_mov_b32 s94, 0xaaaa5555
  s_mov_b32 s95, 0x00000000
  s_mov_b32 s96, 0x55555555
  s_mov_b32 s97, 0x55555555
  v_pk_fma_f32 v[52:53], v[24:25], v[228:229], v[48:49] op_sel:[1,0,0] op_sel_hi:[1,1,0]
  v_pk_fma_f32 v[54:55], v[24:25], v[230:231], v[48:49] op_sel:[1,0,0] op_sel_hi:[1,1,0]
  v_pk_fma_f32 v[60:61], v[26:27], v[228:229], v[48:49] op_sel:[1,0,0] op_sel_hi:[1,1,0]
  v_pk_fma_f32 v[62:63], v[26:27], v[230:231], v[48:49] op_sel:[1,0,0] op_sel_hi:[1,1,0]
  v_pk_fma_f32 v[204:205], v[204:205], v[24:25], v[52:53] op_sel_hi:[1,0,1]
  v_pk_fma_f32 v[206:207], v[206:207], v[24:25], v[54:55] op_sel_hi:[1,0,1]
  v_pk_fma_f32 v[208:209], v[208:209], v[26:27], v[60:61] op_sel_hi:[1,0,1]
  v_pk_fma_f32 v[210:211], v[210:211], v[26:27], v[62:63] op_sel_hi:[1,0,1]
  v_pk_fma_f32 v[56:57], v[204:205], v[44:45], v[46:47] op_sel_hi:[1,0,0]
  v_pk_fma_f32 v[64:65], v[208:209], v[44:45], v[46:47] op_sel_hi:[1,0,0]
  v_pk_fma_f32 v[58:59], v[206:207], v[44:45], v[46:47] op_sel_hi:[1,0,0]
  v_pk_fma_f32 v[66:67], v[210:211], v[44:45], v[46:47] op_sel_hi:[1,0,0]
  v_exp_f32 v56, v56 clamp
  v_exp_f32 v64, v64 clamp
  v_exp_f32 v57, v57 clamp
  v_exp_f32 v65, v65 clamp
  v_exp_f32 v58, v58 clamp
  v_exp_f32 v66, v66 clamp
  v_exp_f32 v59, v59 clamp
  v_exp_f32 v67, v67 clamp
  v_max_f32 v204, v48, v204
  v_max_f32 v208, v48, v208
  v_max_f32 v205, v48, v205
  v_max_f32 v209, v48, v209
  v_max_f32 v206, v48, v206
  v_max_f32 v210, v48, v210
  v_max_f32 v207, v48, v207
  v_max_f32 v211, v48, v211
  v_pk_add_f32 v[204:205], v[204:205], v[56:57]
  v_pk_add_f32 v[208:209], v[208:209], v[64:65]
  v_pk_add_f32 v[206:207], v[206:207], v[58:59]
  v_pk_add_f32 v[210:211], v[210:211], v[66:67]
  v_cvt_pk_bf16_f32 v70, v204, v205
  v_cvt_pk_bf16_f32 v71, v206, v207
  v_cvt_pk_bf16_f32 v76, v208, v209
  v_cvt_pk_bf16_f32 v77, v210, v211
  v_pk_fma_f32 v[52:53], v[24:25], v[232:233], v[48:49] op_sel:[1,0,0] op_sel_hi:[1,1,0]
  v_pk_fma_f32 v[54:55], v[24:25], v[234:235], v[48:49] op_sel:[1,0,0] op_sel_hi:[1,1,0]
  v_pk_fma_f32 v[60:61], v[26:27], v[232:233], v[48:49] op_sel:[1,0,0] op_sel_hi:[1,1,0]
  v_pk_fma_f32 v[62:63], v[26:27], v[234:235], v[48:49] op_sel:[1,0,0] op_sel_hi:[1,1,0]
  v_pk_fma_f32 v[212:213], v[212:213], v[24:25], v[52:53] op_sel_hi:[1,0,1]
  v_pk_fma_f32 v[214:215], v[214:215], v[24:25], v[54:55] op_sel_hi:[1,0,1]
  v_pk_fma_f32 v[216:217], v[216:217], v[26:27], v[60:61] op_sel_hi:[1,0,1]
  v_pk_fma_f32 v[218:219], v[218:219], v[26:27], v[62:63] op_sel_hi:[1,0,1]
  v_pk_fma_f32 v[56:57], v[212:213], v[44:45], v[46:47] op_sel_hi:[1,0,0]
  v_pk_fma_f32 v[64:65], v[216:217], v[44:45], v[46:47] op_sel_hi:[1,0,0]
  v_pk_fma_f32 v[58:59], v[214:215], v[44:45], v[46:47] op_sel_hi:[1,0,0]
  v_pk_fma_f32 v[66:67], v[218:219], v[44:45], v[46:47] op_sel_hi:[1,0,0]
  v_exp_f32 v56, v56 clamp
  v_exp_f32 v64, v64 clamp
  v_exp_f32 v57, v57 clamp
  v_exp_f32 v65, v65 clamp
  v_exp_f32 v58, v58 clamp
  v_exp_f32 v66, v66 clamp
  v_exp_f32 v59, v59 clamp
  v_exp_f32 v67, v67 clamp
  v_max_f32 v212, v48, v212
  v_max_f32 v216, v48, v216
  v_max_f32 v213, v48, v213
  v_max_f32 v217, v48, v217
  v_max_f32 v214, v48, v214
  v_max_f32 v218, v48, v218
  v_max_f32 v215, v48, v215
  v_max_f32 v219, v48, v219
  v_pk_add_f32 v[212:213], v[212:213], v[56:57]
  v_pk_add_f32 v[216:217], v[216:217], v[64:65]
  v_pk_add_f32 v[214:215], v[214:215], v[58:59]
  v_pk_add_f32 v[218:219], v[218:219], v[66:67]
  v_cvt_pk_bf16_f32 v68, v212, v213
  v_cvt_pk_bf16_f32 v69, v214, v215
  v_cvt_pk_bf16_f32 v74, v216, v217
  v_cvt_pk_bf16_f32 v75, v218, v219
  v_pk_fma_f32 v[52:53], v[24:25], v[236:237], v[48:49] op_sel:[1,0,0] op_sel_hi:[1,1,0]
  v_pk_fma_f32 v[54:55], v[24:25], v[238:239], v[48:49] op_sel:[1,0,0] op_sel_hi:[1,1,0]
  v_pk_fma_f32 v[60:61], v[26:27], v[236:237], v[48:49] op_sel:[1,0,0] op_sel_hi:[1,1,0]
  v_pk_fma_f32 v[62:63], v[26:27], v[238:239], v[48:49] op_sel:[1,0,0] op_sel_hi:[1,1,0]
  v_pk_fma_f32 v[220:221], v[220:221], v[24:25], v[52:53] op_sel_hi:[1,0,1]
  v_pk_fma_f32 v[222:223], v[222:223], v[24:25], v[54:55] op_sel_hi:[1,0,1]
  v_pk_fma_f32 v[224:225], v[224:225], v[26:27], v[60:61] op_sel_hi:[1,0,1]
  v_pk_fma_f32 v[226:227], v[226:227], v[26:27], v[62:63] op_sel_hi:[1,0,1]
  v_pk_fma_f32 v[56:57], v[220:221], v[44:45], v[46:47] op_sel_hi:[1,0,0]
  v_pk_fma_f32 v[64:65], v[224:225], v[44:45], v[46:47] op_sel_hi:[1,0,0]
  v_pk_fma_f32 v[58:59], v[222:223], v[44:45], v[46:47] op_sel_hi:[1,0,0]
  v_pk_fma_f32 v[66:67], v[226:227], v[44:45], v[46:47] op_sel_hi:[1,0,0]
  v_exp_f32 v56, v56 clamp
  v_exp_f32 v64, v64 clamp
  v_exp_f32 v57, v57 clamp
  v_exp_f32 v65, v65 clamp
  v_exp_f32 v58, v58 clamp
  v_exp_f32 v66, v66 clamp
  v_exp_f32 v59, v59 clamp
  v_exp_f32 v67, v67 clamp
  v_max_f32 v220, v48, v220
  v_max_f32 v224, v48, v224
  v_max_f32 v221, v48, v221
  v_max_f32 v225, v48, v225
  v_max_f32 v222, v48, v222
  v_max_f32 v226, v48, v226
  v_max_f32 v223, v48, v223
  v_max_f32 v227, v48, v227
  v_pk_add_f32 v[220:221], v[220:221], v[56:57]
  v_pk_add_f32 v[224:225], v[224:225], v[64:65]
  v_pk_add_f32 v[222:223], v[222:223], v[58:59]
  v_pk_add_f32 v[226:227], v[226:227], v[66:67]
  v_cvt_pk_bf16_f32 v72, v220, v221
  v_cvt_pk_bf16_f32 v73, v222, v223
  v_cvt_pk_bf16_f32 v78, v224, v225
  v_cvt_pk_bf16_f32 v79, v226, v227
  s_waitcnt lgkmcnt(0)
  s_mov_b32 s0, 0x1000000
L_lwga:
  ds_read_b32 v52, v12 offset:32
  s_sub_u32 s0, s0, 1
  s_cselect_b32 s1, 0, 4
  s_waitcnt lgkmcnt(0)
  v_readfirstlane_b32 s79, v52
  s_nop 0
  s_cmp_lt_u32 s79, s1
  s_cbranch_scc1 L_lwga
  buffer_load_dwordx4 v[92:95], v2, s[52:55], s74 offen offset:3072 sc1
  buffer_load_dwordx4 v[88:91], v2, s[52:55], s74 offen offset:2048 sc1
  buffer_load_dwordx4 v[80:83], v2, s[52:55], s74 offen offset:0 sc1
  buffer_load_dwordx4 v[84:87], v2, s[52:55], s74 offen offset:1024 sc1
  s_waitcnt vmcnt(3)
  v_cvt_pk_bf16_f32 v150, v92, v93
  v_cvt_pk_bf16_f32 v151, v94, v95
  s_waitcnt vmcnt(2)
  v_cvt_pk_bf16_f32 v148, v88, v89
  v_cvt_pk_bf16_f32 v149, v90, v91
  v_permlane32_swap_b32 v150, v152
  v_permlane32_swap_b32 v151, v153
  v_cndmask_b32 v152, 0, v152, s[94:95]
  v_cndmask_b32 v153, 0, v153, s[94:95]
  v_cndmask_b32 v104, v152, v148, s[96:97]
  v_cndmask_b32 v106, v148, v152, s[96:97]
  v_cndmask_b32 v105, v153, v149, s[96:97]
  v_cndmask_b32 v107, v149, v153, s[96:97]
  v_cndmask_b32 v98, 0, v150, s[90:91]
  v_cndmask_b32 v100, 0, v150, s[92:93]
  v_cndmask_b32 v99, 0, v151, s[90:91]
  v_cndmask_b32 v101, 0, v151, s[92:93]
  v_mfma_f32_16x16x32_bf16 v[116:119], v[104:107], v[68:71], v[156:159]
  v_mfma_f32_16x16x32_bf16 v[120:123], v[104:107], v[70:73], v[156:159]
  v_mfma_f32_16x16x32_bf16 v[132:135], v[104:107], v[74:77], v[156:159]
  v_mfma_f32_16x16x32_bf16 v[136:139], v[104:107], v[76:79], v[156:159]
  s_waitcnt vmcnt(1)
  v_cvt_pk_bf16_f32 v96, v80, v81
  v_cvt_pk_bf16_f32 v97, v82, v83
  s_waitcnt vmcnt(0)
  v_cvt_pk_bf16_f32 v102, v84, v85
  v_cvt_pk_bf16_f32 v103, v86, v87
  v_mfma_f32_16x16x32_bf16 v[108:111], v[96:99], v[68:71], 0
  s_nop 0
  v_mfma_f32_16x16x32_bf16 v[112:115], v[100:103], v[70:73], 0
  v_mfma_f32_16x16x32_bf16 v[124:127], v[96:99], v[74:77], 0
  v_mfma_f32_16x16x32_bf16 v[128:131], v[100:103], v[76:79], 0
  v_rcp_f32 v148, v116
  v_rcp_f32 v149, v121
  v_rcp_f32 v152, v132
  v_rcp_f32 v153, v137
  v_mul_f32 v150, v148, v118
  v_mul_f32 v151, v149, v123
  v_cvt_pk_bf16_f32 v163, v150, v151
  buffer_store_dword v163, v162, s[52:55], s72 offen offset:1024 sc1
  v_mul_f32 v154, v152, v134
  v_mul_f32 v155, v153, v139
  v_cvt_pk_bf16_f32 v164, v154, v155
  buffer_store_dword v164, v162, s[52:55], s73 offen offset:1024 sc1
  v_pk_mul_f32 v[108:109], v[108:109], v[148:149] op_sel_hi:[1,0]
  v_pk_mul_f32 v[110:111], v[110:111], v[148:149] op_sel_hi:[1,0]
  v_pk_mul_f32 v[112:113], v[148:149], v[112:113] op_sel:[1,0] op_sel_hi:[1,1]
  v_pk_mul_f32 v[114:115], v[148:149], v[114:115] op_sel:[1,0] op_sel_hi:[1,1]
  v_cvt_pk_bf16_f32 v140, v108, v109
  v_cvt_pk_bf16_f32 v141, v110, v111
  v_cvt_pk_bf16_f32 v142, v112, v113
  v_cvt_pk_bf16_f32 v143, v114, v115
  buffer_store_dwordx4 v[140:143], v2, s[52:55], s72 offen sc1
  v_pk_mul_f32 v[124:125], v[124:125], v[152:153] op_sel_hi:[1,0]
  v_pk_mul_f32 v[126:127], v[126:127], v[152:153] op_sel_hi:[1,0]
  v_pk_mul_f32 v[128:129], v[152:153], v[128:129] op_sel:[1,0] op_sel_hi:[1,1]
  v_pk_mul_f32 v[130:131], v[152:153], v[130:131] op_sel:[1,0] op_sel_hi:[1,1]
  v_cvt_pk_bf16_f32 v144, v124, v125
  v_cvt_pk_bf16_f32 v145, v126, v127
  v_cvt_pk_bf16_f32 v146, v128, v129
  v_cvt_pk_bf16_f32 v147, v130, v131
  buffer_store_dwordx4 v[144:147], v2, s[52:55], s73 offen sc1
  v_lshrrev_b32 v20, 4, v1
  s_xor_b32 s76, s81, 1
  s_mul_i32 s76, s76, 51200
  s_lshl_b32 s77, s84, 5
  s_add_u32 s77, s77, s76
  v_add_u32 v252, s77, v2
  s_lshl_b32 s77, s85, 5
  s_add_u32 s77, s77, s76
  v_add_u32 v253, s77, v2
  s_lshl_b32 s77, s86, 5
  s_add_u32 s77, s77, s76
  v_add_u32 v254, s77, v2
  s_movk_i32 s79, 1024
  s_mul_i32 s77, s80, 3072
  s_add_u32 s77, s77, 38912
  s_add_u32 s78, s77, s76
  v_add_u32 v8, s78, v2
  s_sub_u32 s78, 51200, s76
  s_add_u32 s78, s78, s77
  v_add_u32 v9, s78, v2
  v_lshlrev_b32 v255, 3, v1
  v_mul_u32_u24 v10, 1024, v20
  v_add3_u32 v10, v10, v2, s79
  v_and_b32 v18, 15, v1
  v_mul_u32_u24 v18, 160, v18
  v_lshl_add_u32 v18, v20, 3, v18
  s_mul_i32 s76, s80, 2560
  s_add_u32 s76, s76, 106496
  s_add_u32 s77, s76, s84
  v_add_u32 v55, s77, v18
  s_add_u32 s77, s76, s86
  v_add_u32 v56, s77, v18
  s_lshl_b32 s74, s83, 4
  s_lshl_b32 s75, s81, 3
  s_add_u32 s74, s74, s75
  s_mul_i32 s74, s74, 1280
  s_add_u32 s74, s74, 1048576
  s_mul_i32 s100, s28, 7
  s_mul_i32 s76, s28, 6
  s_add_u32 s76, s76, 12
  s_cmp_lt_u32 s28, 12
  s_cselect_b32 s100, s100, s76
  s_add_u32 s10, s100, s26
  s_lshl_b32 s10, s10, 10
  s_add_u32 s10, s10, 20037632
  s_and_b32 s101, s100, 1
  s_lshl_b32 s76, s100, 5
  s_sub_u32 s78, 3456, s76
  s_add_u32 s64, s14, s76
  s_addc_u32 s65, s15, 0
  s_mov_b32 s66, s78
  s_mov_b32 s67, 0x20000
  s_mul_i32 s36, s31, 5
  s_add_u32 s36, s36, 1
  s_lshr_b32 s36, s36, 1
  s_mul_i32 s37, s83, 20
  s_add_u32 s36, s36, s37
  s_cmp_eq_u32 s88, 0
  s_cselect_b32 s37, 2, -1
  s_add_u32 s37, s37, s36
  s_lshl_b32 s37, s37, 10
  s_lshl_b32 s38, s88, 9
  s_add_u32 s37, s37, s38
  s_add_u32 s37, s37, 5242880
  s_cmp_lg_u32 s81, 0
  s_cselect_b32 s37, 33554432, s37
  s_cselect_b32 s7, 0, 1.0
  s_add_u32 s36, s36, s81
  s_lshl_b32 s36, s36, 10
  s_add_u32 s36, s36, 5242880
  s_lshl_b32 s38, s83, 3
  s_add_u32 s38, s38, s31
  s_lshl_b32 s38, s38, 8
  s_lshl_b32 s75, s81, 7
  s_add_u32 s38, s38, s75
  s_add_u32 s38, s38, 8388608
  s_mul_i32 s39, s31, 5120
  s_mul_i32 s75, s26, 40960
  s_add_u32 s39, s39, s75
  s_add_u32 s39, s39, 17825792
  s_mul_i32 s11, s26, 5120
  s_lshl_b32 s48, s101, 5
  s_lshl_b32 s78, s80, 6
  s_add_u32 s48, s48, s78
  s_cmp_eq_u32 s48, 224
  s_cselect_b32 s48, 0, s48
  s_lshl_b32 s51, s48, 5
  s_lshl_b32 s44, s27, 3
  s_lshl_b32 s78, s81, 2
  s_add_u32 s44, s44, s78
  s_mul_i32 s45, s44, 54
  s_mul_i32 s44, s44, 20
  s_add_u32 s44, s44, s80
  s_lshl_b32 s44, s44, 10
  s_add_u32 s44, s44, 5242880
  s_mul_i32 s46, s81, 20480
  s_lshl_b32 s78, s80, 10
  s_add_u32 s46, s46, s78
  s_lshl_b32 s78, s100, 5
  s_add_u32 s78, s78, s48
  s_lshr_b32 s79, s78, 6
  s_add_u32 s45, s45, s79
  s_lshl_b32 s45, s45, 10
  s_bfe_u32 s79, s78, 0x10005
  s_lshl_b32 s79, s79, 9
  s_add_u32 s45, s45, s79
  s_add_u32 s45, s45, 9437184
  s_cmp_ge_u32 s28, 12
  s_cselect_b32 s78, 33554432, s45
  s_cmp_eq_u32 s80, 3
  s_cselect_b32 s45, s78, s45
  s_lshl_b32 s47, s27, 3
  s_add_u32 s47, s47, s26
  s_lshl_b32 s47, s47, 11
  s_add_u32 s47, s47, 8388608
  s_lshl_b32 s49, s26, 7
  s_add_u32 s49, s49, 40960
  s_lshl_b32 s50, s81, 9
  s_add_u32 s50, s50, 40960
  s_lshl_b32 s1, s27, 7
  s_add_u32 s1, s1, 73728
  s_mov_b64 exec, 1
  s_waitcnt vmcnt(0)
  ds_add_rtn_u32 v15, v12, v13 offset:20
  s_mov_b64 exec, -1
  s_waitcnt lgkmcnt(0)
  v_readfirstlane_b32 s79, v15
  s_nop 0
  s_cmp_lg_u32 s79, 3
  s_cbranch_scc1 L_lsB
  s_atomic_add s3, s[24:25], s1
L_lsB:
  s_barrier
  ds_read_b64 v[24:25], v55
  ds_read_b64 v[26:27], v55 offset:32
  ds_read_b64 v[28:29], v56
  ds_read_b128 v[92:95], v252 offset:0
  ds_read_b128 v[96:99], v252 offset:1024
  ds_read_b128 v[100:103], v253 offset:0
  ds_read_b128 v[104:107], v253 offset:1024
  ds_read_b128 v[108:111], v254 offset:0
  ds_read_b128 v[112:115], v252 offset:5120
  ds_read_b128 v[116:119], v252 offset:6144
  ds_read_b128 v[120:123], v253 offset:5120
  ds_read_b128 v[124:127], v253 offset:6144
  ds_read_b128 v[128:131], v254 offset:5120
  ds_read_b128 v[132:135], v252 offset:10240
  ds_read_b128 v[136:139], v252 offset:11264
  ds_read_b128 v[140:143], v253 offset:10240
  ds_read_b128 v[144:147], v253 offset:11264
  ds_read_b128 v[148:151], v254 offset:10240
  ds_read_b128 v[152:155], v252 offset:15360
  ds_read_b128 v[156:159], v252 offset:16384
  ds_read_b128 v[160:163], v253 offset:15360
  ds_read_b128 v[164:167], v253 offset:16384
  ds_read_b128 v[168:171], v254 offset:15360
  ds_read_b128 v[172:175], v252 offset:20480
  ds_read_b128 v[176:179], v252 offset:21504
  ds_read_b128 v[180:183], v253 offset:20480
  ds_read_b128 v[184:187], v253 offset:21504
  ds_read_b128 v[188:191], v254 offset:20480
  ds_read_b128 v[192:195], v252 offset:25600
  ds_read_b128 v[196:199], v252 offset:26624
  ds_read_b128 v[200:203], v253 offset:25600
  ds_read_b128 v[204:207], v253 offset:26624
  ds_read_b128 v[208:211], v254 offset:25600
  ds_read_b128 v[212:215], v252 offset:30720
  ds_read_b128 v[216:219], v252 offset:31744
  ds_read_b128 v[220:223], v253 offset:30720
  ds_read_b128 v[224:227], v253 offset:31744
  ds_read_b128 v[228:231], v254 offset:30720
  ds_read_b128 v[232:235], v252 offset:35840
  ds_read_b128 v[236:239], v252 offset:36864
  ds_read_b128 v[240:243], v253 offset:35840
  ds_read_b128 v[244:247], v253 offset:36864
  ds_read_b128 v[248:251], v254 offset:35840
  s_waitcnt lgkmcnt(15)
  v_lshlrev_b32 v32, 16, v24
  v_and_b32 v33, 0xffff0000, v24
  v_lshlrev_b32 v34, 16, v25
  v_and_b32 v35, 0xffff0000, v25
  v_lshlrev_b32 v36, 16, v26
  v_and_b32 v37, 0xffff0000, v26
  v_lshlrev_b32 v38, 16, v27
  v_and_b32 v39, 0xffff0000, v27
  v_lshlrev_b32 v48, 16, v28
  v_and_b32 v49, 0xffff0000, v28
  v_lshlrev_b32 v50, 16, v29
  v_and_b32 v51, 0xffff0000, v29
  v_mul_f32 v48, s7, v48
  v_mul_f32 v49, s7, v49
  v_mul_f32 v50, s7, v50
  v_mul_f32 v51, s7, v51
  s_branch L_p1join
L_p1c:
  v_mov_b32 v16, 0
  v_mov_b32 v17, 0
  v_mov_b32 v18, 0
  v_mov_b32 v19, 0
  v_mov_b32 v12, 155648
  v_mov_b32 v13, 1
  ds_write_b128 v12, v[16:19]
  ds_write_b128 v12, v[16:19] offset:16
  ds_write_b128 v12, v[16:19] offset:32
  v_mov_b32 v4, 0x3f803f80
  v_mov_b32 v5, 0x3f803f80
  v_mov_b32 v6, 0x3f803f80
  v_mov_b32 v7, 0x3f803f80
  v_lshrrev_b32 v20, 4, v1
  v_and_b32 v23, 15, v1
  s_lshl_b32 s76, s80, 12
  v_lshrrev_b32 v16, 1, v23
  v_xor_b32 v16, v16, v20
  v_lshlrev_b32 v16, 4, v16
  v_lshl_add_u32 v16, v23, 7, v16
  v_add_u32 v8, s76, v16
  v_xor_b32 v9, 64, v8
  v_add_u32 v10, 65536, v8
  v_add_u32 v11, 65536, v9
  v_lshrrev_b32 v20, 4, v1
  v_bfe_u32 v21, v1, 2, 2
  v_and_b32 v22, 3, v1
  v_lshl_add_u32 v16, v20, 3, v21
  v_lshlrev_b32 v16, 7, v16
  v_and_b32 v17, 1, v20
  v_lshlrev_b32 v17, 1, v17
  v_lshrrev_b32 v18, 1, v21
  v_or_b32 v17, v17, v18
  v_lshlrev_b32 v17, 5, v17
  v_and_b32 v23, 1, v22
  v_mul_u32_u24 v23, 40, v23
  s_xor_b32 s76, s28, 0
  s_and_b32 s76, s76, 3
  s_lshl_b32 s76, s76, 4
  s_mov_b32 s77, 16384
  v_lshl_add_u32 v18, v22, 3, s76
  v_xor_b32 v19, v18, v17
  v_add3_u32 v24, v19, v16, s77
  v_add_u32 v18, 40, v18
  v_xor_b32 v19, v18, v17
  v_add3_u32 v25, v19, v16, s77
  v_add3_u32 v18, v23, s76, 32
  v_xor_b32 v19, v18, v17
  v_add3_u32 v28, v19, v16, s77
  v_xor_b32 v26, 16, v24
  v_xor_b32 v27, 16, v25
  v_xor_b32 v16, 16, v28
  v_add_u32 v26, 8192, v26
  v_add_u32 v27, 8192, v27
  v_add_u32 v16, 8192, v16
  v_cmp_lt_u32 vcc, 1, v22
  s_nop 1
  v_cndmask_b32 v28, v28, v16, vcc
  v_add_u32 v29, 65536, v24
  v_add_u32 v30, 65536, v25
  v_add_u32 v31, 65536, v26
  v_add_u32 v32, 65536, v27
  v_add_u32 v33, 65536, v28
  s_waitcnt lgkmcnt(0)
  s_mov_b32 s52, s24
  s_mov_b32 s53, s25
  s_mov_b32 s54, 33554432
  s_mov_b32 s55, 0x20000
  s_and_b32 s72, s2, 7
  s_lshl_b32 s29, s72, 1
  s_and_b32 s76, s82, 1
  s_add_u32 s29, s29, s76
  s_lshr_b32 s30, s82, 1
  s_and_b32 s31, s30, 7
  s_and_b32 s88, s31, 1
  s_lshl_b32 s83, s29, 3
  s_lshr_b32 s76, s30, 3
  s_lshl_b32 s76, s76, 2
  s_add_u32 s83, s83, s76
  s_add_u32 s83, s83, s80
  s_lshl_b32 s76, s88, 5
  s_lshl_b32 s77, s81, 6
  s_add_u32 s84, s76, s77
  s_xor_b32 s77, s77, 64
  s_add_u32 s85, s76, s77
  s_cmp_eq_u32 s88, 0
  s_cselect_b32 s86, 128, 0
  s_mul_i32 s87, s83, 20480
  s_mul_i32 s76, s31, 160
  s_add_u32 s87, s87, s76
  s_lshl_b32 s89, s26, 10
  s_sub_u32 s77, 819200, s76
  s_sub_u32 s78, 1280, s76
  s_add_u32 s40, s8, s76
  s_addc_u32 s41, s9, 0
  s_mov_b32 s42, s77
  s_mov_b32 s43, 0x20000
  s_add_u32 s68, s18, s76
  s_addc_u32 s69, s19, 0
  s_mov_b32 s70, s78
  s_mov_b32 s71, 0x20000
  s_mov_b32 s60, s22
  s_mov_b32 s61, s23
  s_mov_b32 s62, 256
  s_mov_b32 s63, 0x20000
  s_mov_b32 s56, s20
  s_mov_b32 s57, s21
  s_mov_b32 s58, 2621440
  s_mov_b32 s59, 0x20000
  v_mov_b32 v4, 0x3f803f80
  v_mov_b32 v5, 0x3f803f80
  v_mov_b32 v6, 0x3f803f80
  v_mov_b32 v7, 0x3f803f80
  v_and_b32 v16, 15, v1
  v_mul_u32_u24 v16, 1280, v16
  v_lshrrev_b32 v17, 4, v1
  v_lshl_add_u32 v3, v17, 3, v16
  s_lshl_b32 s101, s2, 2
  s_add_u32 s101, s101, s80
  s_lshl_b32 s72, s101, 10
  s_add_u32 s77, s72, 24117248
  s_cmp_lt_u32 s101, 64
  s_cselect_b32 s72, s77, s72
  s_cmp_ge_u32 s101, 84
  s_cselect_b32 s72, 33554432, s72
  v_lshrrev_b32 v20, 3, v1
  v_and_b32 v21, 7, v1
  v_lshlrev_b32 v21, 4, v21
  s_movk_i32 s76, 3456
  s_movk_i32 s10, 2428
  s_cmp_lt_u32 s101, 540
  s_cselect_b32 s48, s16, s12
  s_cselect_b32 s49, s17, s13
  s_mov_b32 s50, 2211840
  s_mov_b32 s51, 0x20000
  s_cselect_b32 s76, 1280, s76
  s_cselect_b32 s77, 0, 540
  s_cselect_b32 s10, 6554, s10
  v_mad_u32_u24 v68, v20, s76, v21
  s_lshl_b32 s11, s76, 3
  s_sub_u32 s77, s101, s77
  s_mul_i32 s10, s10, s77
  s_lshr_b32 s10, s10, 16
  s_mul_i32 s10, s10, s76
  s_mul_i32 s10, s10, 31
  s_lshl_b32 s77, s77, 7
  s_add_u32 s10, s10, s77
  s_movk_i32 s76, 3456
  v_mad_u32_u24 v69, v20, s76, v21
  s_mov_b32 s44, s12
  s_mov_b32 s45, s13
  s_mov_b32 s46, 2211840
  s_mov_b32 s47, 0x20000
  s_mov_b32 s64, s14
  s_mov_b32 s65, s15
  s_mov_b32 s66, 3456
  s_mov_b32 s67, 0x20000
  s_mov_b32 s32, s18
  s_mov_b32 s33, s19
  s_mov_b32 s34, 1280
  s_mov_b32 s35, 0x20000
  s_mov_b32 s36, s8
  s_mov_b32 s37, s9
  s_mov_b32 s38, 819200
  s_mov_b32 s39, 0x20000
  s_mov_b32 s90, 0xff00ff00
  s_mov_b32 s91, 0xff00ff00
  s_mov_b32 s92, 0xffff0000
  s_mov_b32 s93, 0x00000000
  s_mov_b32 s94, 0xf0f0f0f0
  s_mov_b32 s95, 0xf0f0f0f0
  v_mov_b32 v72, 0x3fb8aa3b
  v_mov_b32 v74, 0xb5c1a2a0
  v_mov_b32 v76, 0x358637bd
  v_cndmask_b32 v77, v76, 0, s[90:91]
  s_lshl_b32 s76, s80, 7
  s_add_u32 s76, s76, 156672
  v_and_b32 v16, 48, v1
  v_add_u32 v78, s76, v16
  s_mul_i32 s76, s80, 5120
  s_add_u32 s76, s76, 0
  v_add_u32 v79, s76, v2
  v_and_b32 v17, 3, v1
  v_bfe_u32 v18, v1, 2, 2
  v_lshl_add_u32 v17, v17, 2, v18
  v_add_u32 v17, v17, v16
  v_lshl_add_u32 v80, v17, 4, s76
  s_lshl_b32 s76, s80, 10
  v_lshl_add_u32 v81, v1, 2, s76
  s_lshl_b32 s77, s28, 12
  s_add_u32 s77, s77, 24117248
  v_add_u32 v82, s77, v81
  s_lshl_b32 s76, s80, 11
  s_add_u32 s76, s76, 122880
  v_add_u32 v70, s76, v2
  v_lshrrev_b32 v16, 2, v1
  v_lshlrev_b32 v16, 7, v16
  v_and_b32 v17, 3, v1
  v_lshl_add_u32 v16, v17, 3, v16
  v_add_u32 v71, s76, v16
  s_lshl_b32 s100, s101, 12
  s_add_u32 s100, s100, 17825792
  s_lshl_b32 s76, s80, 6
  v_add_u32 v16, s76, v1
  s_movk_i32 s76, 1120
  v_mul_u32_u24 v17, 6554, v16
  v_lshrrev_b32 v17, 16, v17
  v_lshlrev_b32 v18, 4, v16
  v_mad_u32_u24 v84, v17, s76, v18
  v_add_u32 v16, 256, v16
  v_mul_u32_u24 v17, 6554, v16
  v_lshrrev_b32 v17, 16, v17
  v_lshlrev_b32 v18, 4, v16
  v_mad_u32_u24 v85, v17, s76, v18
  v_add_u32 v16, 256, v16
  v_mul_u32_u24 v17, 6554, v16
  v_lshrrev_b32 v17, 16, v17
  v_lshlrev_b32 v18, 4, v16
  v_mad_u32_u24 v86, v17, s76, v18
  v_add_u32 v16, 256, v16
  s_lshl_b32 s73, s27, 3
  s_lshr_b32 s77, s28, 1
  s_add_u32 s73, s73, s77
  s_lshl_b32 s73, s73, 1
  s_add_u32 s73, s73, s80
  s_and_b32 s77, s28, 7
  s_bitcmp1_b32 0xa5, s77
  s_cselect_b32 s73, s73, 999
  s_cmp_ge_u32 s80, 2
  s_cselect_b32 s73, 999, s73
  s_mul_i32 s76, s73, 6554
  s_lshr_b32 s76, s76, 16
  s_mul_i32 s77, s76, 10
  s_sub_u32 s74, s73, s77
  s_lshl_b32 s74, s74, 7
  s_cmp_ge_u32 s76, 10
  s_cselect_b32 s77, 409600, 0
  s_cselect_b32 s78, 10, 0
  s_add_u32 s74, s74, s77
  s_sub_u32 s76, s76, s78
  s_cmp_ge_u32 s76, 8
  s_cselect_b32 s77, 2, 0
  s_sub_u32 s77, s76, s77
  s_mul_i32 s77, s77, 51200
  s_sub_u32 s78, s76, 6
  s_mul_i32 s79, s78, 204800
  s_add_u32 s79, s79, 20480
  v_lshrrev_b32 v16, 3, v1
  v_and_b32 v17, 3, v16
  v_mul_u32_u24 v17, 20, v17
  v_lshrrev_b32 v18, 5, v1
  v_add_u32 v17, v17, v18
  s_cmp_lt_u32 s78, 2
  s_cselect_b32 s77, s79, s77
  s_cselect_b32 s75, 1, 0
  s_cselect_b64 vcc, -1, 0
  s_add_u32 s74, s74, s77
  v_cndmask_b32 v16, v16, v17, vcc
  v_mul_u32_u24 v16, 1280, v16
  v_and_b32 v17, 7, v1
  v_lshl_add_u32 v87, v17, 4, v16
  v_mov_b32 v16, 0
  v_mov_b32 v17, 0
  v_mov_b32 v18, 0
  v_mov_b32 v19, 0
  v_lshlrev_b32 v20, 7, v1
  s_waitcnt lgkmcnt(0)
  s_barrier
  ds_read_b128 v[164:167], v8 offset:0
  ds_read_b128 v[168:171], v8 offset:2048
  ds_read_b64_tr_b16 v[180:181], v24 offset:0
  ds_read_b64_tr_b16 v[182:183], v24 offset:512
  ds_read_b64_tr_b16 v[184:185], v25 offset:0
  ds_read_b64_tr_b16 v[186:187], v25 offset:512
  ds_read_b64_tr_b16 v[188:189], v26 offset:0
  ds_read_b64_tr_b16 v[190:191], v26 offset:512
  ds_read_b64_tr_b16 v[192:193], v27 offset:0
  ds_read_b64_tr_b16 v[194:195], v27 offset:512
  ds_read_b64_tr_b16 v[196:197], v28 offset:0
  ds_read_b64_tr_b16 v[198:199], v28 offset:512
  s_waitcnt lgkmcnt(0)
  v_mfma_f32_16x16x32_bf16 v[128:131], v[4:7], v[180:183], 0
  ds_read_b128 v[172:175], v9 offset:0
  v_mfma_f32_16x16x32_bf16 v[88:91], v[164:167], v[180:183], 0
  ds_read_b128 v[176:179], v9 offset:2048
  v_mfma_f32_16x16x32_bf16 v[92:95], v[168:171], v[180:183], 0
  ds_read_b64_tr_b16 v[200:201], v24 offset:4096
  v_mfma_f32_16x16x32_bf16 v[132:135], v[4:7], v[184:187], 0
  ds_read_b64_tr_b16 v[202:203], v24 offset:4608
  v_mfma_f32_16x16x32_bf16 v[96:99], v[164:167], v[184:187], 0
  ds_read_b64_tr_b16 v[204:205], v25 offset:4096
  v_mfma_f32_16x16x32_bf16 v[100:103], v[168:171], v[184:187], 0
  ds_read_b64_tr_b16 v[206:207], v25 offset:4608
  v_mfma_f32_16x16x32_bf16 v[136:139], v[4:7], v[188:191], 0
  ds_read_b64_tr_b16 v[208:209], v26 offset:4096
  v_mfma_f32_16x16x32_bf16 v[104:107], v[164:167], v[188:191], 0
  ds_read_b64_tr_b16 v[210:211], v26 offset:4608
  v_mfma_f32_16x16x32_bf16 v[108:111], v[168:171], v[188:191], 0
  ds_read_b64_tr_b16 v[212:213], v27 offset:4096
  v_mfma_f32_16x16x32_bf16 v[140:143], v[4:7], v[192:195], 0
  ds_read_b64_tr_b16 v[214:215], v27 offset:4608
  v_mfma_f32_16x16x32_bf16 v[112:115], v[164:167], v[192:195], 0
  ds_read_b64_tr_b16 v[216:217], v28 offset:4096
  v_mfma_f32_16x16x32_bf16 v[116:119], v[168:171], v[192:195], 0
  ds_read_b64_tr_b16 v[218:219], v28 offset:4608
  v_mfma_f32_16x16x32_bf16 v[144:147], v[4:7], v[196:199], 0
  v_mfma_f32_16x16x32_bf16 v[120:123], v[164:167], v[196:199], 0
  v_mfma_f32_16x16x32_bf16 v[124:127], v[168:171], v[196:199], 0
  buffer_store_dwordx4 v[16:19], v2, s[52:55], s72 offen sc1
  s_cmp_lg_u32 s26, 7
  s_cbranch_scc1 L_ntb
  buffer_load_dword v14, v20, s[64:67], 0 offen
  buffer_load_dword v14, v20, s[32:35], 0 offen
L_ntb:
  s_cmp_ge_u32 s73, 200
  s_cbranch_scc1 L_nwj
  s_cmp_lg_u32 s75, 0
  s_movk_i32 s76, 10240
  s_cselect_b32 s76, 2560, s76
  s_movk_i32 s77, 25600
  s_cselect_b32 s77, 102400, s77
  s_add_u32 s78, s74, s76
  s_add_u32 s79, s74, s77
  s_add_u32 s76, s79, s76
  buffer_load_dwordx4 v[36:39], v87, s[36:39], s74 offen nt
  buffer_load_dwordx4 v[40:43], v87, s[36:39], s78 offen nt
  buffer_load_dwordx4 v[44:47], v87, s[36:39], s79 offen nt
  buffer_load_dwordx4 v[48:51], v87, s[36:39], s76 offen nt
L_nwj:
  s_barrier
  s_waitcnt lgkmcnt(0)
  v_mfma_f32_16x16x32_bf16 v[128:131], v[4:7], v[200:203], v[128:131]
  ds_read_b128 v[164:167], v8 offset:32768
  v_mfma_f32_16x16x32_bf16 v[88:91], v[172:175], v[200:203], v[88:91]
  ds_read_b128 v[168:171], v8 offset:34816
  v_mfma_f32_16x16x32_bf16 v[92:95], v[176:179], v[200:203], v[92:95]
  ds_read_b64_tr_b16 v[180:181], v24 offset:32768
  v_mfma_f32_16x16x32_bf16 v[132:135], v[4:7], v[204:207], v[132:135]
  ds_read_b64_tr_b16 v[182:183], v24 offset:33280
  v_mfma_f32_16x16x32_bf16 v[96:99], v[172:175], v[204:207], v[96:99]
  ds_read_b64_tr_b16 v[184:185], v25 offset:32768
  v_mfma_f32_16x16x32_bf16 v[100:103], v[176:179], v[204:207], v[100:103]
  ds_read_b64_tr_b16 v[186:187], v25 offset:33280
  v_mfma_f32_16x16x32_bf16 v[136:139], v[4:7], v[208:211], v[136:139]
  ds_read_b64_tr_b16 v[188:189], v26 offset:32768
  v_mfma_f32_16x16x32_bf16 v[104:107], v[172:175], v[208:211], v[104:107]
  ds_read_b64_tr_b16 v[190:191], v26 offset:33280
  v_mfma_f32_16x16x32_bf16 v[108:111], v[176:179], v[208:211], v[108:111]
  ds_read_b64_tr_b16 v[192:193], v27 offset:32768
  v_mfma_f32_16x16x32_bf16 v[140:143], v[4:7], v[212:215], v[140:143]
  ds_read_b64_tr_b16 v[194:195], v27 offset:33280
  v_mfma_f32_16x16x32_bf16 v[112:115], v[172:175], v[212:215], v[112:115]
  ds_read_b64_tr_b16 v[196:197], v28 offset:32768
  v_mfma_f32_16x16x32_bf16 v[116:119], v[176:179], v[212:215], v[116:119]
  ds_read_b64_tr_b16 v[198:199], v28 offset:33280
  v_mfma_f32_16x16x32_bf16 v[144:147], v[4:7], v[216:219], v[144:147]
  v_mfma_f32_16x16x32_bf16 v[120:123], v[172:175], v[216:219], v[120:123]
  v_mfma_f32_16x16x32_bf16 v[124:127], v[176:179], v[216:219], v[124:127]
  s_waitcnt lgkmcnt(0)
  v_mfma_f32_16x16x32_bf16 v[128:131], v[4:7], v[180:183], v[128:131]
  ds_read_b128 v[172:175], v9 offset:32768
  v_mfma_f32_16x16x32_bf16 v[88:91], v[164:167], v[180:183], v[88:91]
  ds_read_b128 v[176:179], v9 offset:34816
  v_mfma_f32_16x16x32_bf16 v[92:95], v[168:171], v[180:183], v[92:95]
  ds_read_b64_tr_b16 v[200:201], v24 offset:36864
  v_mfma_f32_16x16x32_bf16 v[132:135], v[4:7], v[184:187], v[132:135]
  ds_read_b64_tr_b16 v[202:203], v24 offset:37376
  v_mfma_f32_16x16x32_bf16 v[96:99], v[164:167], v[184:187], v[96:99]
  ds_read_b64_tr_b16 v[204:205], v25 offset:36864
  v_mfma_f32_16x16x32_bf16 v[100:103], v[168:171], v[184:187], v[100:103]
  ds_read_b64_tr_b16 v[206:207], v25 offset:37376
  v_mfma_f32_16x16x32_bf16 v[136:139], v[4:7], v[188:191], v[136:139]
  ds_read_b64_tr_b16 v[208:209], v26 offset:36864
  v_mfma_f32_16x16x32_bf16 v[104:107], v[164:167], v[188:191], v[104:107]
  ds_read_b64_tr_b16 v[210:211], v26 offset:37376
  v_mfma_f32_16x16x32_bf16 v[108:111], v[168:171], v[188:191], v[108:111]
  ds_read_b64_tr_b16 v[212:213], v27 offset:36864
  v_mfma_f32_16x16x32_bf16 v[140:143], v[4:7], v[192:195], v[140:143]
  ds_read_b64_tr_b16 v[214:215], v27 offset:37376
  v_mfma_f32_16x16x32_bf16 v[112:115], v[164:167], v[192:195], v[112:115]
  ds_read_b64_tr_b16 v[216:217], v28 offset:36864
  v_mfma_f32_16x16x32_bf16 v[116:119], v[168:171], v[192:195], v[116:119]
  ds_read_b64_tr_b16 v[218:219], v28 offset:37376
  v_mfma_f32_16x16x32_bf16 v[144:147], v[4:7], v[196:199], v[144:147]
  v_mfma_f32_16x16x32_bf16 v[120:123], v[164:167], v[196:199], v[120:123]
  v_mfma_f32_16x16x32_bf16 v[124:127], v[168:171], v[196:199], v[124:127]
  s_barrier
  s_waitcnt lgkmcnt(0)
  v_mfma_f32_16x16x32_bf16 v[128:131], v[4:7], v[200:203], v[128:131]
  ds_read_b128 v[164:167], v10 offset:0
  v_mfma_f32_16x16x32_bf16 v[88:91], v[172:175], v[200:203], v[88:91]
  ds_read_b128 v[168:171], v10 offset:2048
  v_mfma_f32_16x16x32_bf16 v[92:95], v[176:179], v[200:203], v[92:95]
  ds_read_b64_tr_b16 v[180:181], v29 offset:0
  v_mfma_f32_16x16x32_bf16 v[132:135], v[4:7], v[204:207], v[132:135]
  ds_read_b64_tr_b16 v[182:183], v29 offset:512
  v_mfma_f32_16x16x32_bf16 v[96:99], v[172:175], v[204:207], v[96:99]
  ds_read_b64_tr_b16 v[184:185], v30 offset:0
  v_mfma_f32_16x16x32_bf16 v[100:103], v[176:179], v[204:207], v[100:103]
  ds_read_b64_tr_b16 v[186:187], v30 offset:512
  v_mfma_f32_16x16x32_bf16 v[136:139], v[4:7], v[208:211], v[136:139]
  ds_read_b64_tr_b16 v[188:189], v31 offset:0
  v_mfma_f32_16x16x32_bf16 v[104:107], v[172:175], v[208:211], v[104:107]
  ds_read_b64_tr_b16 v[190:191], v31 offset:512
  v_mfma_f32_16x16x32_bf16 v[108:111], v[176:179], v[208:211], v[108:111]
  ds_read_b64_tr_b16 v[192:193], v32 offset:0
  v_mfma_f32_16x16x32_bf16 v[140:143], v[4:7], v[212:215], v[140:143]
  ds_read_b64_tr_b16 v[194:195], v32 offset:512
  v_mfma_f32_16x16x32_bf16 v[112:115], v[172:175], v[212:215], v[112:115]
  ds_read_b64_tr_b16 v[196:197], v33 offset:0
  v_mfma_f32_16x16x32_bf16 v[116:119], v[176:179], v[212:215], v[116:119]
  ds_read_b64_tr_b16 v[198:199], v33 offset:512
  v_mfma_f32_16x16x32_bf16 v[144:147], v[4:7], v[216:219], v[144:147]
  v_mfma_f32_16x16x32_bf16 v[120:123], v[172:175], v[216:219], v[120:123]
  v_mfma_f32_16x16x32_bf16 v[124:127], v[176:179], v[216:219], v[124:127]
  s_waitcnt vmcnt(0)
  s_cmp_ge_u32 s101, 84
  s_cbranch_scc1 L_nozsig
  v_mov_b32 v16, 0
  s_mov_b64 exec, 1
  buffer_atomic_add v13, v16, s[60:63], 0 offen sc1
  s_mov_b64 exec, -1
L_nozsig:
  s_cmp_ge_u32 s73, 200
  s_cbranch_scc1 L_nwp
  s_lshl_b32 s76, s73, 12
  s_add_u32 s76, s76, 23068672
  ds_write_b128 v70, v[36:39] offset:8192
  ds_write_b128 v70, v[40:43] offset:9216
  ds_read_b64_tr_b16 v[148:149], v71 offset:8192
  ds_read_b64_tr_b16 v[152:153], v71 offset:8224
  ds_read_b64_tr_b16 v[156:157], v71 offset:8256
  ds_read_b64_tr_b16 v[160:161], v71 offset:8288
  ds_write_b128 v70, v[44:47] offset:8192
  ds_write_b128 v70, v[48:51] offset:9216
  ds_read_b64_tr_b16 v[150:151], v71 offset:8192
  ds_read_b64_tr_b16 v[154:155], v71 offset:8224
  ds_read_b64_tr_b16 v[158:159], v71 offset:8256
  ds_read_b64_tr_b16 v[162:163], v71 offset:8288
  s_waitcnt lgkmcnt(0)
  buffer_store_dwordx4 v[148:151], v2, s[52:55], s76 offen offset:0 sc1
  s_waitcnt lgkmcnt(0)
  buffer_store_dwordx4 v[152:155], v2, s[52:55], s76 offen offset:1024 sc1
  s_waitcnt lgkmcnt(0)
  buffer_store_dwordx4 v[156:159], v2, s[52:55], s76 offen offset:2048 sc1
  s_waitcnt lgkmcnt(0)
  buffer_store_dwordx4 v[160:163], v2, s[52:55], s76 offen offset:3072 sc1
L_nwp:
  s_waitcnt lgkmcnt(0)
  v_mfma_f32_16x16x32_bf16 v[128:131], v[4:7], v[180:183], v[128:131]
  ds_read_b128 v[172:175], v11 offset:0
  v_mfma_f32_16x16x32_bf16 v[88:91], v[164:167], v[180:183], v[88:91]
  ds_read_b128 v[176:179], v11 offset:2048
  v_mfma_f32_16x16x32_bf16 v[92:95], v[168:171], v[180:183], v[92:95]
  ds_read_b64_tr_b16 v[200:201], v29 offset:4096
  v_mfma_f32_16x16x32_bf16 v[132:135], v[4:7], v[184:187], v[132:135]
  ds_read_b64_tr_b16 v[202:203], v29 offset:4608
  v_mfma_f32_16x16x32_bf16 v[96:99], v[164:167], v[184:187], v[96:99]
  ds_read_b64_tr_b16 v[204:205], v30 offset:4096
  v_mfma_f32_16x16x32_bf16 v[100:103], v[168:171], v[184:187], v[100:103]
  ds_read_b64_tr_b16 v[206:207], v30 offset:4608
  v_mfma_f32_16x16x32_bf16 v[136:139], v[4:7], v[188:191], v[136:139]
  ds_read_b64_tr_b16 v[208:209], v31 offset:4096
  v_mfma_f32_16x16x32_bf16 v[104:107], v[164:167], v[188:191], v[104:107]
  ds_read_b64_tr_b16 v[210:211], v31 offset:4608
  v_mfma_f32_16x16x32_bf16 v[108:111], v[168:171], v[188:191], v[108:111]
  ds_read_b64_tr_b16 v[212:213], v32 offset:4096
  v_mfma_f32_16x16x32_bf16 v[140:143], v[4:7], v[192:195], v[140:143]
  ds_read_b64_tr_b16 v[214:215], v32 offset:4608
  v_mfma_f32_16x16x32_bf16 v[112:115], v[164:167], v[192:195], v[112:115]
  ds_read_b64_tr_b16 v[216:217], v33 offset:4096
  v_mfma_f32_16x16x32_bf16 v[116:119], v[168:171], v[192:195], v[116:119]
  ds_read_b64_tr_b16 v[218:219], v33 offset:4608
  v_mfma_f32_16x16x32_bf16 v[144:147], v[4:7], v[196:199], v[144:147]
  v_mfma_f32_16x16x32_bf16 v[120:123], v[164:167], v[196:199], v[120:123]
  v_mfma_f32_16x16x32_bf16 v[124:127], v[168:171], v[196:199], v[124:127]
  s_barrier
  s_waitcnt lgkmcnt(0)
  v_mfma_f32_16x16x32_bf16 v[128:131], v[4:7], v[200:203], v[128:131]
  ds_read_b128 v[164:167], v10 offset:32768
  v_mfma_f32_16x16x32_bf16 v[88:91], v[172:175], v[200:203], v[88:91]
  ds_read_b128 v[168:171], v10 offset:34816
  v_mfma_f32_16x16x32_bf16 v[92:95], v[176:179], v[200:203], v[92:95]
  ds_read_b64_tr_b16 v[180:181], v29 offset:32768
  v_mfma_f32_16x16x32_bf16 v[132:135], v[4:7], v[204:207], v[132:135]
  ds_read_b64_tr_b16 v[182:183], v29 offset:33280
  v_mfma_f32_16x16x32_bf16 v[96:99], v[172:175], v[204:207], v[96:99]
  ds_read_b64_tr_b16 v[184:185], v30 offset:32768
  v_mfma_f32_16x16x32_bf16 v[100:103], v[176:179], v[204:207], v[100:103]
  ds_read_b64_tr_b16 v[186:187], v30 offset:33280
  v_mfma_f32_16x16x32_bf16 v[136:139], v[4:7], v[208:211], v[136:139]
  ds_read_b64_tr_b16 v[188:189], v31 offset:32768
  v_mfma_f32_16x16x32_bf16 v[104:107], v[172:175], v[208:211], v[104:107]
  ds_read_b64_tr_b16 v[190:191], v31 offset:33280
  v_mfma_f32_16x16x32_bf16 v[108:111], v[176:179], v[208:211], v[108:111]
  ds_read_b64_tr_b16 v[192:193], v32 offset:32768
  v_mfma_f32_16x16x32_bf16 v[140:143], v[4:7], v[212:215], v[140:143]
  ds_read_b64_tr_b16 v[194:195], v32 offset:33280
  v_mfma_f32_16x16x32_bf16 v[112:115], v[172:175], v[212:215], v[112:115]
  ds_read_b64_tr_b16 v[196:197], v33 offset:32768
  v_mfma_f32_16x16x32_bf16 v[116:119], v[176:179], v[212:215], v[116:119]
  ds_read_b64_tr_b16 v[198:199], v33 offset:33280
  v_mfma_f32_16x16x32_bf16 v[144:147], v[4:7], v[216:219], v[144:147]
  v_mfma_f32_16x16x32_bf16 v[120:123], v[172:175], v[216:219], v[120:123]
  v_mfma_f32_16x16x32_bf16 v[124:127], v[176:179], v[216:219], v[124:127]
  s_waitcnt lgkmcnt(0)
  v_mfma_f32_16x16x32_bf16 v[128:131], v[4:7], v[180:183], v[128:131]
  ds_read_b128 v[172:175], v11 offset:32768
  v_mfma_f32_16x16x32_bf16 v[88:91], v[164:167], v[180:183], v[88:91]
  ds_read_b128 v[176:179], v11 offset:34816
  v_mfma_f32_16x16x32_bf16 v[92:95], v[168:171], v[180:183], v[92:95]
  ds_read_b64_tr_b16 v[200:201], v29 offset:36864
  v_mfma_f32_16x16x32_bf16 v[132:135], v[4:7], v[184:187], v[132:135]
  ds_read_b64_tr_b16 v[202:203], v29 offset:37376
  v_mfma_f32_16x16x32_bf16 v[96:99], v[164:167], v[184:187], v[96:99]
  ds_read_b64_tr_b16 v[204:205], v30 offset:36864
  v_mfma_f32_16x16x32_bf16 v[100:103], v[168:171], v[184:187], v[100:103]
  ds_read_b64_tr_b16 v[206:207], v30 offset:37376
  v_mfma_f32_16x16x32_bf16 v[136:139], v[4:7], v[188:191], v[136:139]
  ds_read_b64_tr_b16 v[208:209], v31 offset:36864
  v_mfma_f32_16x16x32_bf16 v[104:107], v[164:167], v[188:191], v[104:107]
  ds_read_b64_tr_b16 v[210:211], v31 offset:37376
  v_mfma_f32_16x16x32_bf16 v[108:111], v[168:171], v[188:191], v[108:111]
  ds_read_b64_tr_b16 v[212:213], v32 offset:36864
  v_mfma_f32_16x16x32_bf16 v[140:143], v[4:7], v[192:195], v[140:143]
  ds_read_b64_tr_b16 v[214:215], v32 offset:37376
  v_mfma_f32_16x16x32_bf16 v[112:115], v[164:167], v[192:195], v[112:115]
  ds_read_b64_tr_b16 v[216:217], v33 offset:36864
  v_mfma_f32_16x16x32_bf16 v[116:119], v[168:171], v[192:195], v[116:119]
  ds_read_b64_tr_b16 v[218:219], v33 offset:37376
  v_mfma_f32_16x16x32_bf16 v[144:147], v[4:7], v[196:199], v[144:147]
  v_mfma_f32_16x16x32_bf16 v[120:123], v[164:167], v[196:199], v[120:123]
  v_mfma_f32_16x16x32_bf16 v[124:127], v[168:171], v[196:199], v[124:127]
  s_barrier
  s_waitcnt lgkmcnt(0)
  v_mfma_f32_16x16x32_bf16 v[128:131], v[4:7], v[200:203], v[128:131]
  ds_read_b128 v[164:167], v8 offset:0
  v_mfma_f32_16x16x32_bf16 v[88:91], v[172:175], v[200:203], v[88:91]
  ds_read_b128 v[168:171], v8 offset:2048
  v_mfma_f32_16x16x32_bf16 v[92:95], v[176:179], v[200:203], v[92:95]
  ds_read_b64_tr_b16 v[180:181], v24 offset:0
  v_mfma_f32_16x16x32_bf16 v[132:135], v[4:7], v[204:207], v[132:135]
  ds_read_b64_tr_b16 v[182:183], v24 offset:512
  v_mfma_f32_16x16x32_bf16 v[96:99], v[172:175], v[204:207], v[96:99]
  ds_read_b64_tr_b16 v[184:185], v25 offset:0
  v_mfma_f32_16x16x32_bf16 v[100:103], v[176:179], v[204:207], v[100:103]
  ds_read_b64_tr_b16 v[186:187], v25 offset:512
  v_mfma_f32_16x16x32_bf16 v[136:139], v[4:7], v[208:211], v[136:139]
  ds_read_b64_tr_b16 v[188:189], v26 offset:0
  v_mfma_f32_16x16x32_bf16 v[104:107], v[172:175], v[208:211], v[104:107]
  ds_read_b64_tr_b16 v[190:191], v26 offset:512
  v_mfma_f32_16x16x32_bf16 v[108:111], v[176:179], v[208:211], v[108:111]
  ds_read_b64_tr_b16 v[192:193], v27 offset:0
  v_mfma_f32_16x16x32_bf16 v[140:143], v[4:7], v[212:215], v[140:143]
  ds_read_b64_tr_b16 v[194:195], v27 offset:512
  v_mfma_f32_16x16x32_bf16 v[112:115], v[172:175], v[212:215], v[112:115]
  ds_read_b64_tr_b16 v[196:197], v28 offset:0
  v_mfma_f32_16x16x32_bf16 v[116:119], v[176:179], v[212:215], v[116:119]
  ds_read_b64_tr_b16 v[198:199], v28 offset:512
  v_mfma_f32_16x16x32_bf16 v[144:147], v[4:7], v[216:219], v[144:147]
  v_mfma_f32_16x16x32_bf16 v[120:123], v[172:175], v[216:219], v[120:123]
  v_mfma_f32_16x16x32_bf16 v[124:127], v[176:179], v[216:219], v[124:127]
  s_waitcnt lgkmcnt(0)
  v_mfma_f32_16x16x32_bf16 v[128:131], v[4:7], v[180:183], v[128:131]
  ds_read_b128 v[172:175], v9 offset:0
  v_mfma_f32_16x16x32_bf16 v[88:91], v[164:167], v[180:183], v[88:91]
  ds_read_b128 v[176:179], v9 offset:2048
  v_mfma_f32_16x16x32_bf16 v[92:95], v[168:171], v[180:183], v[92:95]
  ds_read_b64_tr_b16 v[200:201], v24 offset:4096
  v_mfma_f32_16x16x32_bf16 v[132:135], v[4:7], v[184:187], v[132:135]
  ds_read_b64_tr_b16 v[202:203], v24 offset:4608
  v_mfma_f32_16x16x32_bf16 v[96:99], v[164:167], v[184:187], v[96:99]
  ds_read_b64_tr_b16 v[204:205], v25 offset:4096
  v_mfma_f32_16x16x32_bf16 v[100:103], v[168:171], v[184:187], v[100:103]
  ds_read_b64_tr_b16 v[206:207], v25 offset:4608
  v_mfma_f32_16x16x32_bf16 v[136:139], v[4:7], v[188:191], v[136:139]
  ds_read_b64_tr_b16 v[208:209], v26 offset:4096
  v_mfma_f32_16x16x32_bf16 v[104:107], v[164:167], v[188:191], v[104:107]
  ds_read_b64_tr_b16 v[210:211], v26 offset:4608
  v_mfma_f32_16x16x32_bf16 v[108:111], v[168:171], v[188:191], v[108:111]
  ds_read_b64_tr_b16 v[212:213], v27 offset:4096
  v_mfma_f32_16x16x32_bf16 v[140:143], v[4:7], v[192:195], v[140:143]
  ds_read_b64_tr_b16 v[214:215], v27 offset:4608
  v_mfma_f32_16x16x32_bf16 v[112:115], v[164:167], v[192:195], v[112:115]
  ds_read_b64_tr_b16 v[216:217], v28 offset:4096
  v_mfma_f32_16x16x32_bf16 v[116:119], v[168:171], v[192:195], v[116:119]
  ds_read_b64_tr_b16 v[218:219], v28 offset:4608
  v_mfma_f32_16x16x32_bf16 v[144:147], v[4:7], v[196:199], v[144:147]
  v_mfma_f32_16x16x32_bf16 v[120:123], v[164:167], v[196:199], v[120:123]
  v_mfma_f32_16x16x32_bf16 v[124:127], v[168:171], v[196:199], v[124:127]
  s_barrier
  s_waitcnt lgkmcnt(0)
  v_mfma_f32_16x16x32_bf16 v[128:131], v[4:7], v[200:203], v[128:131]
  ds_read_b128 v[164:167], v8 offset:32768
  v_mfma_f32_16x16x32_bf16 v[88:91], v[172:175], v[200:203], v[88:91]
  ds_read_b128 v[168:171], v8 offset:34816
  v_mfma_f32_16x16x32_bf16 v[92:95], v[176:179], v[200:203], v[92:95]
  ds_read_b64_tr_b16 v[180:181], v24 offset:32768
  v_mfma_f32_16x16x32_bf16 v[132:135], v[4:7], v[204:207], v[132:135]
  ds_read_b64_tr_b16 v[182:183], v24 offset:33280
  v_mfma_f32_16x16x32_bf16 v[96:99], v[172:175], v[204:207], v[96:99]
  ds_read_b64_tr_b16 v[184:185], v25 offset:32768
  v_mfma_f32_16x16x32_bf16 v[100:103], v[176:179], v[204:207], v[100:103]
  ds_read_b64_tr_b16 v[186:187], v25 offset:33280
  v_mfma_f32_16x16x32_bf16 v[136:139], v[4:7], v[208:211], v[136:139]
  ds_read_b64_tr_b16 v[188:189], v26 offset:32768
  v_mfma_f32_16x16x32_bf16 v[104:107], v[172:175], v[208:211], v[104:107]
  ds_read_b64_tr_b16 v[190:191], v26 offset:33280
  v_mfma_f32_16x16x32_bf16 v[108:111], v[176:179], v[208:211], v[108:111]
  ds_read_b64_tr_b16 v[192:193], v27 offset:32768
  v_mfma_f32_16x16x32_bf16 v[140:143], v[4:7], v[212:215], v[140:143]
  ds_read_b64_tr_b16 v[194:195], v27 offset:33280
  v_mfma_f32_16x16x32_bf16 v[112:115], v[172:175], v[212:215], v[112:115]
  ds_read_b64_tr_b16 v[196:197], v28 offset:32768
  v_mfma_f32_16x16x32_bf16 v[116:119], v[176:179], v[212:215], v[116:119]
  ds_read_b64_tr_b16 v[198:199], v28 offset:33280
  v_mfma_f32_16x16x32_bf16 v[144:147], v[4:7], v[216:219], v[144:147]
  v_mfma_f32_16x16x32_bf16 v[120:123], v[172:175], v[216:219], v[120:123]
  v_mfma_f32_16x16x32_bf16 v[124:127], v[176:179], v[216:219], v[124:127]
  s_waitcnt lgkmcnt(0)
  v_mfma_f32_16x16x32_bf16 v[128:131], v[4:7], v[180:183], v[128:131]
  ds_read_b128 v[172:175], v9 offset:32768
  v_mfma_f32_16x16x32_bf16 v[88:91], v[164:167], v[180:183], v[88:91]
  ds_read_b128 v[176:179], v9 offset:34816
  v_mfma_f32_16x16x32_bf16 v[92:95], v[168:171], v[180:183], v[92:95]
  ds_read_b64_tr_b16 v[200:201], v24 offset:36864
  v_mfma_f32_16x16x32_bf16 v[132:135], v[4:7], v[184:187], v[132:135]
  ds_read_b64_tr_b16 v[202:203], v24 offset:37376
  v_mfma_f32_16x16x32_bf16 v[96:99], v[164:167], v[184:187], v[96:99]
  ds_read_b64_tr_b16 v[204:205], v25 offset:36864
  v_mfma_f32_16x16x32_bf16 v[100:103], v[168:171], v[184:187], v[100:103]
  ds_read_b64_tr_b16 v[206:207], v25 offset:37376
  v_mfma_f32_16x16x32_bf16 v[136:139], v[4:7], v[188:191], v[136:139]
  ds_read_b64_tr_b16 v[208:209], v26 offset:36864
  v_mfma_f32_16x16x32_bf16 v[104:107], v[164:167], v[188:191], v[104:107]
  ds_read_b64_tr_b16 v[210:211], v26 offset:37376
  v_mfma_f32_16x16x32_bf16 v[108:111], v[168:171], v[188:191], v[108:111]
  ds_read_b64_tr_b16 v[212:213], v27 offset:36864
  v_mfma_f32_16x16x32_bf16 v[140:143], v[4:7], v[192:195], v[140:143]
  ds_read_b64_tr_b16 v[214:215], v27 offset:37376
  v_mfma_f32_16x16x32_bf16 v[112:115], v[164:167], v[192:195], v[112:115]
  ds_read_b64_tr_b16 v[216:217], v28 offset:36864
  v_mfma_f32_16x16x32_bf16 v[116:119], v[168:171], v[192:195], v[116:119]
  ds_read_b64_tr_b16 v[218:219], v28 offset:37376
  v_mfma_f32_16x16x32_bf16 v[144:147], v[4:7], v[196:199], v[144:147]
  v_mfma_f32_16x16x32_bf16 v[120:123], v[164:167], v[196:199], v[120:123]
  v_mfma_f32_16x16x32_bf16 v[124:127], v[168:171], v[196:199], v[124:127]
  s_barrier
  s_waitcnt lgkmcnt(0)
  v_mfma_f32_16x16x32_bf16 v[128:131], v[4:7], v[200:203], v[128:131]
  ds_read_b128 v[164:167], v10 offset:0
  v_mfma_f32_16x16x32_bf16 v[88:91], v[172:175], v[200:203], v[88:91]
  ds_read_b128 v[168:171], v10 offset:2048
  v_mfma_f32_16x16x32_bf16 v[92:95], v[176:179], v[200:203], v[92:95]
  ds_read_b64_tr_b16 v[180:181], v29 offset:0
  v_mfma_f32_16x16x32_bf16 v[132:135], v[4:7], v[204:207], v[132:135]
  ds_read_b64_tr_b16 v[182:183], v29 offset:512
  v_mfma_f32_16x16x32_bf16 v[96:99], v[172:175], v[204:207], v[96:99]
  ds_read_b64_tr_b16 v[184:185], v30 offset:0
  v_mfma_f32_16x16x32_bf16 v[100:103], v[176:179], v[204:207], v[100:103]
  ds_read_b64_tr_b16 v[186:187], v30 offset:512
  v_mfma_f32_16x16x32_bf16 v[136:139], v[4:7], v[208:211], v[136:139]
  ds_read_b64_tr_b16 v[188:189], v31 offset:0
  v_mfma_f32_16x16x32_bf16 v[104:107], v[172:175], v[208:211], v[104:107]
  ds_read_b64_tr_b16 v[190:191], v31 offset:512
  v_mfma_f32_16x16x32_bf16 v[108:111], v[176:179], v[208:211], v[108:111]
  ds_read_b64_tr_b16 v[192:193], v32 offset:0
  v_mfma_f32_16x16x32_bf16 v[140:143], v[4:7], v[212:215], v[140:143]
  ds_read_b64_tr_b16 v[194:195], v32 offset:512
  v_mfma_f32_16x16x32_bf16 v[112:115], v[172:175], v[212:215], v[112:115]
  ds_read_b64_tr_b16 v[196:197], v33 offset:0
  v_mfma_f32_16x16x32_bf16 v[116:119], v[176:179], v[212:215], v[116:119]
  ds_read_b64_tr_b16 v[198:199], v33 offset:512
  v_mfma_f32_16x16x32_bf16 v[144:147], v[4:7], v[216:219], v[144:147]
  v_mfma_f32_16x16x32_bf16 v[120:123], v[172:175], v[216:219], v[120:123]
  v_mfma_f32_16x16x32_bf16 v[124:127], v[176:179], v[216:219], v[124:127]
  s_waitcnt lgkmcnt(0)
  v_mfma_f32_16x16x32_bf16 v[128:131], v[4:7], v[180:183], v[128:131]
  ds_read_b128 v[172:175], v11 offset:0
  v_mfma_f32_16x16x32_bf16 v[88:91], v[164:167], v[180:183], v[88:91]
  ds_read_b128 v[176:179], v11 offset:2048
  v_mfma_f32_16x16x32_bf16 v[92:95], v[168:171], v[180:183], v[92:95]
  ds_read_b64_tr_b16 v[200:201], v29 offset:4096
  v_mfma_f32_16x16x32_bf16 v[132:135], v[4:7], v[184:187], v[132:135]
  ds_read_b64_tr_b16 v[202:203], v29 offset:4608
  v_mfma_f32_16x16x32_bf16 v[96:99], v[164:167], v[184:187], v[96:99]
  ds_read_b64_tr_b16 v[204:205], v30 offset:4096
  v_mfma_f32_16x16x32_bf16 v[100:103], v[168:171], v[184:187], v[100:103]
  ds_read_b64_tr_b16 v[206:207], v30 offset:4608
  v_mfma_f32_16x16x32_bf16 v[136:139], v[4:7], v[188:191], v[136:139]
  ds_read_b64_tr_b16 v[208:209], v31 offset:4096
  v_mfma_f32_16x16x32_bf16 v[104:107], v[164:167], v[188:191], v[104:107]
  ds_read_b64_tr_b16 v[210:211], v31 offset:4608
  v_mfma_f32_16x16x32_bf16 v[108:111], v[168:171], v[188:191], v[108:111]
  ds_read_b64_tr_b16 v[212:213], v32 offset:4096
  v_mfma_f32_16x16x32_bf16 v[140:143], v[4:7], v[192:195], v[140:143]
  ds_read_b64_tr_b16 v[214:215], v32 offset:4608
  v_mfma_f32_16x16x32_bf16 v[112:115], v[164:167], v[192:195], v[112:115]
  ds_read_b64_tr_b16 v[216:217], v33 offset:4096
  v_mfma_f32_16x16x32_bf16 v[116:119], v[168:171], v[192:195], v[116:119]
  ds_read_b64_tr_b16 v[218:219], v33 offset:4608
  v_mfma_f32_16x16x32_bf16 v[144:147], v[4:7], v[196:199], v[144:147]
  v_mfma_f32_16x16x32_bf16 v[120:123], v[164:167], v[196:199], v[120:123]
  v_mfma_f32_16x16x32_bf16 v[124:127], v[168:171], v[196:199], v[124:127]
  s_barrier
  s_waitcnt lgkmcnt(0)
  v_mfma_f32_16x16x32_bf16 v[128:131], v[4:7], v[200:203], v[128:131]
  ds_read_b128 v[164:167], v10 offset:32768
  v_mfma_f32_16x16x32_bf16 v[88:91], v[172:175], v[200:203], v[88:91]
  ds_read_b128 v[168:171], v10 offset:34816
  v_mfma_f32_16x16x32_bf16 v[92:95], v[176:179], v[200:203], v[92:95]
  ds_read_b64_tr_b16 v[180:181], v29 offset:32768
  v_mfma_f32_16x16x32_bf16 v[132:135], v[4:7], v[204:207], v[132:135]
  ds_read_b64_tr_b16 v[182:183], v29 offset:33280
  v_mfma_f32_16x16x32_bf16 v[96:99], v[172:175], v[204:207], v[96:99]
  ds_read_b64_tr_b16 v[184:185], v30 offset:32768
  v_mfma_f32_16x16x32_bf16 v[100:103], v[176:179], v[204:207], v[100:103]
  ds_read_b64_tr_b16 v[186:187], v30 offset:33280
  v_mfma_f32_16x16x32_bf16 v[136:139], v[4:7], v[208:211], v[136:139]
  ds_read_b64_tr_b16 v[188:189], v31 offset:32768
  v_mfma_f32_16x16x32_bf16 v[104:107], v[172:175], v[208:211], v[104:107]
  ds_read_b64_tr_b16 v[190:191], v31 offset:33280
  v_mfma_f32_16x16x32_bf16 v[108:111], v[176:179], v[208:211], v[108:111]
  ds_read_b64_tr_b16 v[192:193], v32 offset:32768
  v_mfma_f32_16x16x32_bf16 v[140:143], v[4:7], v[212:215], v[140:143]
  ds_read_b64_tr_b16 v[194:195], v32 offset:33280
  v_mfma_f32_16x16x32_bf16 v[112:115], v[172:175], v[212:215], v[112:115]
  ds_read_b64_tr_b16 v[196:197], v33 offset:32768
  v_mfma_f32_16x16x32_bf16 v[116:119], v[176:179], v[212:215], v[116:119]
  ds_read_b64_tr_b16 v[198:199], v33 offset:33280
  v_mfma_f32_16x16x32_bf16 v[144:147], v[4:7], v[216:219], v[144:147]
  v_mfma_f32_16x16x32_bf16 v[120:123], v[172:175], v[216:219], v[120:123]
  v_mfma_f32_16x16x32_bf16 v[124:127], v[176:179], v[216:219], v[124:127]
  s_waitcnt lgkmcnt(0)
  v_mfma_f32_16x16x32_bf16 v[128:131], v[4:7], v[180:183], v[128:131]
  ds_read_b128 v[172:175], v11 offset:32768
  v_mfma_f32_16x16x32_bf16 v[88:91], v[164:167], v[180:183], v[88:91]
  ds_read_b128 v[176:179], v11 offset:34816
  v_mfma_f32_16x16x32_bf16 v[92:95], v[168:171], v[180:183], v[92:95]
  ds_read_b64_tr_b16 v[200:201], v29 offset:36864
  v_mfma_f32_16x16x32_bf16 v[132:135], v[4:7], v[184:187], v[132:135]
  ds_read_b64_tr_b16 v[202:203], v29 offset:37376
  v_mfma_f32_16x16x32_bf16 v[96:99], v[164:167], v[184:187], v[96:99]
  ds_read_b64_tr_b16 v[204:205], v30 offset:36864
  v_mfma_f32_16x16x32_bf16 v[100:103], v[168:171], v[184:187], v[100:103]
  ds_read_b64_tr_b16 v[206:207], v30 offset:37376
  v_mfma_f32_16x16x32_bf16 v[136:139], v[4:7], v[188:191], v[136:139]
  ds_read_b64_tr_b16 v[208:209], v31 offset:36864
  v_mfma_f32_16x16x32_bf16 v[104:107], v[164:167], v[188:191], v[104:107]
  ds_read_b64_tr_b16 v[210:211], v31 offset:37376
  v_mfma_f32_16x16x32_bf16 v[108:111], v[168:171], v[188:191], v[108:111]
  ds_read_b64_tr_b16 v[212:213], v32 offset:36864
  v_mfma_f32_16x16x32_bf16 v[140:143], v[4:7], v[192:195], v[140:143]
  ds_read_b64_tr_b16 v[214:215], v32 offset:37376
  v_mfma_f32_16x16x32_bf16 v[112:115], v[164:167], v[192:195], v[112:115]
  ds_read_b64_tr_b16 v[216:217], v33 offset:36864
  v_mfma_f32_16x16x32_bf16 v[116:119], v[168:171], v[192:195], v[116:119]
  ds_read_b64_tr_b16 v[218:219], v33 offset:37376
  v_mfma_f32_16x16x32_bf16 v[144:147], v[4:7], v[196:199], v[144:147]
  v_mfma_f32_16x16x32_bf16 v[120:123], v[164:167], v[196:199], v[120:123]
  v_mfma_f32_16x16x32_bf16 v[124:127], v[168:171], v[196:199], v[124:127]
  s_barrier
  s_waitcnt lgkmcnt(0)
  v_mfma_f32_16x16x32_bf16 v[128:131], v[4:7], v[200:203], v[128:131]
  ds_read_b128 v[164:167], v8 offset:0
  v_mfma_f32_16x16x32_bf16 v[88:91], v[172:175], v[200:203], v[88:91]
  ds_read_b128 v[168:171], v8 offset:2048
  v_mfma_f32_16x16x32_bf16 v[92:95], v[176:179], v[200:203], v[92:95]
  ds_read_b64_tr_b16 v[180:181], v24 offset:0
  v_mfma_f32_16x16x32_bf16 v[132:135], v[4:7], v[204:207], v[132:135]
  ds_read_b64_tr_b16 v[182:183], v24 offset:512
  v_mfma_f32_16x16x32_bf16 v[96:99], v[172:175], v[204:207], v[96:99]
  ds_read_b64_tr_b16 v[184:185], v25 offset:0
  v_mfma_f32_16x16x32_bf16 v[100:103], v[176:179], v[204:207], v[100:103]
  ds_read_b64_tr_b16 v[186:187], v25 offset:512
  v_mfma_f32_16x16x32_bf16 v[136:139], v[4:7], v[208:211], v[136:139]
  ds_read_b64_tr_b16 v[188:189], v26 offset:0
  v_mfma_f32_16x16x32_bf16 v[104:107], v[172:175], v[208:211], v[104:107]
  ds_read_b64_tr_b16 v[190:191], v26 offset:512
  v_mfma_f32_16x16x32_bf16 v[108:111], v[176:179], v[208:211], v[108:111]
  ds_read_b64_tr_b16 v[192:193], v27 offset:0
  v_mfma_f32_16x16x32_bf16 v[140:143], v[4:7], v[212:215], v[140:143]
  ds_read_b64_tr_b16 v[194:195], v27 offset:512
  v_mfma_f32_16x16x32_bf16 v[112:115], v[172:175], v[212:215], v[112:115]
  ds_read_b64_tr_b16 v[196:197], v28 offset:0
  v_mfma_f32_16x16x32_bf16 v[116:119], v[176:179], v[212:215], v[116:119]
  ds_read_b64_tr_b16 v[198:199], v28 offset:512
  v_mfma_f32_16x16x32_bf16 v[144:147], v[4:7], v[216:219], v[144:147]
  v_mfma_f32_16x16x32_bf16 v[120:123], v[172:175], v[216:219], v[120:123]
  v_mfma_f32_16x16x32_bf16 v[124:127], v[176:179], v[216:219], v[124:127]
  s_waitcnt lgkmcnt(0)
  v_mfma_f32_16x16x32_bf16 v[128:131], v[4:7], v[180:183], v[128:131]
  ds_read_b128 v[172:175], v9 offset:0
  v_mfma_f32_16x16x32_bf16 v[88:91], v[164:167], v[180:183], v[88:91]
  ds_read_b128 v[176:179], v9 offset:2048
  v_mfma_f32_16x16x32_bf16 v[92:95], v[168:171], v[180:183], v[92:95]
  ds_read_b64_tr_b16 v[200:201], v24 offset:4096
  v_mfma_f32_16x16x32_bf16 v[132:135], v[4:7], v[184:187], v[132:135]
  ds_read_b64_tr_b16 v[202:203], v24 offset:4608
  v_mfma_f32_16x16x32_bf16 v[96:99], v[164:167], v[184:187], v[96:99]
  ds_read_b64_tr_b16 v[204:205], v25 offset:4096
  v_mfma_f32_16x16x32_bf16 v[100:103], v[168:171], v[184:187], v[100:103]
  ds_read_b64_tr_b16 v[206:207], v25 offset:4608
  v_mfma_f32_16x16x32_bf16 v[136:139], v[4:7], v[188:191], v[136:139]
  ds_read_b64_tr_b16 v[208:209], v26 offset:4096
  v_mfma_f32_16x16x32_bf16 v[104:107], v[164:167], v[188:191], v[104:107]
  ds_read_b64_tr_b16 v[210:211], v26 offset:4608
  v_mfma_f32_16x16x32_bf16 v[108:111], v[168:171], v[188:191], v[108:111]
  ds_read_b64_tr_b16 v[212:213], v27 offset:4096
  v_mfma_f32_16x16x32_bf16 v[140:143], v[4:7], v[192:195], v[140:143]
  ds_read_b64_tr_b16 v[214:215], v27 offset:4608
  v_mfma_f32_16x16x32_bf16 v[112:115], v[164:167], v[192:195], v[112:115]
  ds_read_b64_tr_b16 v[216:217], v28 offset:4096
  v_mfma_f32_16x16x32_bf16 v[116:119], v[168:171], v[192:195], v[116:119]
  ds_read_b64_tr_b16 v[218:219], v28 offset:4608
  v_mfma_f32_16x16x32_bf16 v[144:147], v[4:7], v[196:199], v[144:147]
  v_mfma_f32_16x16x32_bf16 v[120:123], v[164:167], v[196:199], v[120:123]
  v_mfma_f32_16x16x32_bf16 v[124:127], v[168:171], v[196:199], v[124:127]
  s_barrier
  s_waitcnt lgkmcnt(0)
  v_mfma_f32_16x16x32_bf16 v[128:131], v[4:7], v[200:203], v[128:131]
  ds_read_b128 v[164:167], v8 offset:32768
  v_mfma_f32_16x16x32_bf16 v[88:91], v[172:175], v[200:203], v[88:91]
  ds_read_b128 v[168:171], v8 offset:34816
  v_mfma_f32_16x16x32_bf16 v[92:95], v[176:179], v[200:203], v[92:95]
  ds_read_b64_tr_b16 v[180:181], v24 offset:32768
  v_mfma_f32_16x16x32_bf16 v[132:135], v[4:7], v[204:207], v[132:135]
  ds_read_b64_tr_b16 v[182:183], v24 offset:33280
  v_mfma_f32_16x16x32_bf16 v[96:99], v[172:175], v[204:207], v[96:99]
  ds_read_b64_tr_b16 v[184:185], v25 offset:32768
  v_mfma_f32_16x16x32_bf16 v[100:103], v[176:179], v[204:207], v[100:103]
  ds_read_b64_tr_b16 v[186:187], v25 offset:33280
  v_mfma_f32_16x16x32_bf16 v[136:139], v[4:7], v[208:211], v[136:139]
  ds_read_b64_tr_b16 v[188:189], v26 offset:32768
  v_mfma_f32_16x16x32_bf16 v[104:107], v[172:175], v[208:211], v[104:107]
  ds_read_b64_tr_b16 v[190:191], v26 offset:33280
  v_mfma_f32_16x16x32_bf16 v[108:111], v[176:179], v[208:211], v[108:111]
  ds_read_b64_tr_b16 v[192:193], v27 offset:32768
  v_mfma_f32_16x16x32_bf16 v[140:143], v[4:7], v[212:215], v[140:143]
  ds_read_b64_tr_b16 v[194:195], v27 offset:33280
  v_mfma_f32_16x16x32_bf16 v[112:115], v[172:175], v[212:215], v[112:115]
  ds_read_b64_tr_b16 v[196:197], v28 offset:32768
  v_mfma_f32_16x16x32_bf16 v[116:119], v[176:179], v[212:215], v[116:119]
  ds_read_b64_tr_b16 v[198:199], v28 offset:33280
  v_mfma_f32_16x16x32_bf16 v[144:147], v[4:7], v[216:219], v[144:147]
  v_mfma_f32_16x16x32_bf16 v[120:123], v[172:175], v[216:219], v[120:123]
  v_mfma_f32_16x16x32_bf16 v[124:127], v[176:179], v[216:219], v[124:127]
  s_waitcnt lgkmcnt(0)
  v_mfma_f32_16x16x32_bf16 v[128:131], v[4:7], v[180:183], v[128:131]
  ds_read_b128 v[172:175], v9 offset:32768
  v_mfma_f32_16x16x32_bf16 v[88:91], v[164:167], v[180:183], v[88:91]
  ds_read_b128 v[176:179], v9 offset:34816
  v_mfma_f32_16x16x32_bf16 v[92:95], v[168:171], v[180:183], v[92:95]
  ds_read_b64_tr_b16 v[200:201], v24 offset:36864
  v_mfma_f32_16x16x32_bf16 v[132:135], v[4:7], v[184:187], v[132:135]
  ds_read_b64_tr_b16 v[202:203], v24 offset:37376
  v_mfma_f32_16x16x32_bf16 v[96:99], v[164:167], v[184:187], v[96:99]
  ds_read_b64_tr_b16 v[204:205], v25 offset:36864
  v_mfma_f32_16x16x32_bf16 v[100:103], v[168:171], v[184:187], v[100:103]
  ds_read_b64_tr_b16 v[206:207], v25 offset:37376
  v_mfma_f32_16x16x32_bf16 v[136:139], v[4:7], v[188:191], v[136:139]
  ds_read_b64_tr_b16 v[208:209], v26 offset:36864
  v_mfma_f32_16x16x32_bf16 v[104:107], v[164:167], v[188:191], v[104:107]
  ds_read_b64_tr_b16 v[210:211], v26 offset:37376
  v_mfma_f32_16x16x32_bf16 v[108:111], v[168:171], v[188:191], v[108:111]
  ds_read_b64_tr_b16 v[212:213], v27 offset:36864
  v_mfma_f32_16x16x32_bf16 v[140:143], v[4:7], v[192:195], v[140:143]
  ds_read_b64_tr_b16 v[214:215], v27 offset:37376
  v_mfma_f32_16x16x32_bf16 v[112:115], v[164:167], v[192:195], v[112:115]
  ds_read_b64_tr_b16 v[216:217], v28 offset:36864
  v_mfma_f32_16x16x32_bf16 v[116:119], v[168:171], v[192:195], v[116:119]
  ds_read_b64_tr_b16 v[218:219], v28 offset:37376
  v_mfma_f32_16x16x32_bf16 v[144:147], v[4:7], v[196:199], v[144:147]
  v_mfma_f32_16x16x32_bf16 v[120:123], v[164:167], v[196:199], v[120:123]
  v_mfma_f32_16x16x32_bf16 v[124:127], v[168:171], v[196:199], v[124:127]
  s_waitcnt lgkmcnt(0)
  v_mfma_f32_16x16x32_bf16 v[128:131], v[4:7], v[200:203], v[128:131]
  v_mfma_f32_16x16x32_bf16 v[88:91], v[172:175], v[200:203], v[88:91]
  v_mfma_f32_16x16x32_bf16 v[92:95], v[176:179], v[200:203], v[92:95]
  v_mfma_f32_16x16x32_bf16 v[144:147], v[4:7], v[216:219], v[144:147]
  v_mfma_f32_16x16x32_bf16 v[120:123], v[172:175], v[216:219], v[120:123]
  v_mfma_f32_16x16x32_bf16 v[124:127], v[176:179], v[216:219], v[124:127]
  v_mfma_f32_16x16x32_bf16 v[136:139], v[4:7], v[208:211], v[136:139]
  v_mfma_f32_16x16x32_bf16 v[104:107], v[172:175], v[208:211], v[104:107]
  v_mfma_f32_16x16x32_bf16 v[108:111], v[176:179], v[208:211], v[108:111]
  v_mfma_f32_16x16x32_bf16 v[132:135], v[4:7], v[204:207], v[132:135]
  v_mfma_f32_16x16x32_bf16 v[96:99], v[172:175], v[204:207], v[96:99]
  v_mfma_f32_16x16x32_bf16 v[100:103], v[176:179], v[204:207], v[100:103]
  v_mfma_f32_16x16x32_bf16 v[140:143], v[4:7], v[212:215], v[140:143]
  v_mfma_f32_16x16x32_bf16 v[112:115], v[172:175], v[212:215], v[112:115]
  v_mfma_f32_16x16x32_bf16 v[116:119], v[176:179], v[212:215], v[116:119]
  s_setprio 1
  s_waitcnt vmcnt(0)
  s_barrier
  s_cmp_ge_u32 s73, 200
  s_cbranch_scc1 L_nws
  s_cmp_lg_u32 s80, 0
  s_cbranch_scc1 L_nws
  s_mov_b32 s76, 84992
  s_mov_b64 exec, 0xff
  buffer_atomic_add v13, v20, s[52:55], s76 offen sc1
  s_mov_b64 exec, -1
L_nws:
  ds_read_b128 v[152:155], v78 offset:512
  ds_read_b128 v[148:151], v78 offset:0
  ds_read_b128 v[160:163], v78 offset:576
  ds_read_b128 v[156:159], v78 offset:64
  s_waitcnt lgkmcnt(3)
  v_fma_f32 v220, v128, v152, v76
  v_fma_f32 v221, v128, v153, v76
  v_fma_f32 v222, v128, v154, v76
  v_fma_f32 v223, v128, v155, v76
  s_waitcnt lgkmcnt(1)
  v_fma_f32 v228, v128, v160, v76
  v_fma_f32 v229, v128, v161, v76
  v_fma_f32 v230, v128, v162, v76
  v_fma_f32 v231, v128, v163, v76
  v_fma_f32 v88, v88, v148, v220
  v_fma_f32 v89, v89, v149, v221
  v_fma_f32 v90, v90, v150, v222
  v_fma_f32 v91, v91, v151, v223
  s_waitcnt lgkmcnt(0)
  v_fma_f32 v92, v92, v156, v228
  v_fma_f32 v93, v93, v157, v229
  v_fma_f32 v94, v94, v158, v230
  v_fma_f32 v95, v95, v159, v231
  v_fma_f32 v224, v88, v72, v74
  v_fma_f32 v232, v92, v72, v74
  v_fma_f32 v225, v89, v72, v74
  v_fma_f32 v233, v93, v72, v74
  v_fma_f32 v226, v90, v72, v74
  v_fma_f32 v234, v94, v72, v74
  v_fma_f32 v227, v91, v72, v74
  v_fma_f32 v235, v95, v72, v74
  v_exp_f32 v224, v224 clamp
  v_exp_f32 v232, v232 clamp
  v_exp_f32 v225, v225 clamp
  v_exp_f32 v233, v233 clamp
  v_exp_f32 v226, v226 clamp
  v_exp_f32 v234, v234 clamp
  v_exp_f32 v227, v227 clamp
  v_exp_f32 v235, v235 clamp
  v_max_f32 v88, v76, v88
  v_max_f32 v92, v76, v92
  v_max_f32 v89, v76, v89
  v_max_f32 v93, v76, v93
  v_max_f32 v90, v76, v90
  v_max_f32 v94, v76, v94
  v_max_f32 v91, v76, v91
  v_max_f32 v95, v76, v95
  v_add_f32 v88, v88, v224
  v_add_f32 v92, v92, v232
  v_add_f32 v89, v89, v225
  v_add_f32 v93, v93, v233
  v_add_f32 v90, v90, v226
  v_add_f32 v94, v94, v234
  v_add_f32 v91, v91, v227
  v_add_f32 v95, v95, v235
  v_cvt_pk_bf16_f32 v164, v88, v89
  v_cvt_pk_bf16_f32 v165, v90, v91
  v_cvt_pk_bf16_f32 v166, v92, v93
  v_cvt_pk_bf16_f32 v167, v94, v95
  v_fma_f32 v220, v144, v152, v77
  v_fma_f32 v221, v144, v153, v77
  v_fma_f32 v222, v144, v154, v77
  v_fma_f32 v223, v144, v155, v77
  v_fma_f32 v228, v144, v160, v77
  v_fma_f32 v229, v144, v161, v77
  v_fma_f32 v230, v144, v162, v77
  v_fma_f32 v231, v144, v163, v77
  v_fma_f32 v120, v120, v148, v220
  v_fma_f32 v121, v121, v149, v221
  v_fma_f32 v122, v122, v150, v222
  v_fma_f32 v123, v123, v151, v223
  v_fma_f32 v124, v124, v156, v228
  v_fma_f32 v125, v125, v157, v229
  v_fma_f32 v126, v126, v158, v230
  v_fma_f32 v127, v127, v159, v231
  v_cvt_pk_bf16_f32 v184, v120, v121
  v_cvt_pk_bf16_f32 v185, v122, v123
  v_cvt_pk_bf16_f32 v186, v124, v125
  v_cvt_pk_bf16_f32 v187, v126, v127
  v_fma_f32 v224, v120, v72, v74
  v_fma_f32 v232, v124, v72, v74
  v_fma_f32 v225, v121, v72, v74
  v_fma_f32 v233, v125, v72, v74
  v_fma_f32 v226, v122, v72, v74
  v_fma_f32 v234, v126, v72, v74
  v_fma_f32 v227, v123, v72, v74
  v_fma_f32 v235, v127, v72, v74
  v_exp_f32 v224, v224 clamp
  v_exp_f32 v232, v232 clamp
  v_exp_f32 v225, v225 clamp
  v_exp_f32 v233, v233 clamp
  v_exp_f32 v226, v226 clamp
  v_exp_f32 v234, v234 clamp
  v_exp_f32 v227, v227 clamp
  v_exp_f32 v235, v235 clamp
  v_max_f32 v120, v76, v120
  v_max_f32 v124, v76, v124
  v_max_f32 v121, v76, v121
  v_max_f32 v125, v76, v125
  v_max_f32 v122, v76, v122
  v_max_f32 v126, v76, v126
  v_max_f32 v123, v76, v123
  v_max_f32 v127, v76, v127
  v_add_f32 v120, v120, v224
  v_add_f32 v124, v124, v232
  v_add_f32 v121, v121, v225
  v_add_f32 v125, v125, v233
  v_add_f32 v122, v122, v226
  v_add_f32 v126, v126, v234
  v_add_f32 v123, v123, v227
  v_add_f32 v127, v127, v235
  v_cvt_pk_bf16_f32 v180, v120, v121
  v_cvt_pk_bf16_f32 v181, v122, v123
  v_cvt_pk_bf16_f32 v182, v124, v125
  v_cvt_pk_bf16_f32 v183, v126, v127
  v_cndmask_b32 v184, v4, v184, s[90:91]
  v_cndmask_b32 v185, v4, v185, s[90:91]
  v_cndmask_b32 v186, v4, v186, s[90:91]
  v_cndmask_b32 v187, v4, v187, s[90:91]
  v_mul_f32 v220, v136, v152
  v_mul_f32 v221, v136, v153
  v_mul_f32 v222, v136, v154
  v_mul_f32 v223, v136, v155
  v_mul_f32 v228, v136, v160
  v_mul_f32 v229, v136, v161
  v_mul_f32 v230, v136, v162
  v_mul_f32 v231, v136, v163
  v_mfma_f32_16x16x32_bf16 v[204:207], v[164:167], v[184:187], 0
  v_mfma_f32_16x16x32_bf16 v[212:215], v[180:183], v[184:187], 0
  v_fma_f32 v104, v104, v148, v220
  v_fma_f32 v105, v105, v149, v221
  v_fma_f32 v106, v106, v150, v222
  v_fma_f32 v107, v107, v151, v223
  v_fma_f32 v108, v108, v156, v228
  v_fma_f32 v109, v109, v157, v229
  v_fma_f32 v110, v110, v158, v230
  v_fma_f32 v111, v111, v159, v231
  v_cvt_pk_bf16_f32 v172, v104, v105
  v_cvt_pk_bf16_f32 v173, v106, v107
  v_cvt_pk_bf16_f32 v174, v108, v109
  v_cvt_pk_bf16_f32 v175, v110, v111
  v_fma_f32 v220, v132, v152, v76
  v_fma_f32 v221, v132, v153, v76
  v_fma_f32 v222, v132, v154, v76
  v_fma_f32 v223, v132, v155, v76
  v_fma_f32 v228, v132, v160, v76
  v_fma_f32 v229, v132, v161, v76
  v_fma_f32 v230, v132, v162, v76
  v_fma_f32 v231, v132, v163, v76
  v_mfma_f32_16x16x32_bf16 v[188:191], v[164:167], v[172:175], 0
  v_mfma_f32_16x16x32_bf16 v[196:199], v[180:183], v[172:175], 0
  v_fma_f32 v96, v96, v148, v220
  v_fma_f32 v97, v97, v149, v221
  v_fma_f32 v98, v98, v150, v222
  v_fma_f32 v99, v99, v151, v223
  v_fma_f32 v100, v100, v156, v228
  v_fma_f32 v101, v101, v157, v229
  v_fma_f32 v102, v102, v158, v230
  v_fma_f32 v103, v103, v159, v231
  v_fma_f32 v224, v96, v72, v74
  v_fma_f32 v232, v100, v72, v74
  v_fma_f32 v225, v97, v72, v74
  v_fma_f32 v233, v101, v72, v74
  v_fma_f32 v226, v98, v72, v74
  v_fma_f32 v234, v102, v72, v74
  v_fma_f32 v227, v99, v72, v74
  v_fma_f32 v235, v103, v72, v74
  v_exp_f32 v224, v224 clamp
  v_exp_f32 v232, v232 clamp
  v_exp_f32 v225, v225 clamp
  v_exp_f32 v233, v233 clamp
  v_exp_f32 v226, v226 clamp
  v_exp_f32 v234, v234 clamp
  v_exp_f32 v227, v227 clamp
  v_exp_f32 v235, v235 clamp
  v_max_f32 v96, v76, v96
  v_max_f32 v100, v76, v100
  v_max_f32 v97, v76, v97
  v_max_f32 v101, v76, v101
  v_max_f32 v98, v76, v98
  v_max_f32 v102, v76, v102
  v_max_f32 v99, v76, v99
  v_max_f32 v103, v76, v103
  v_add_f32 v96, v96, v224
  v_add_f32 v100, v100, v232
  v_add_f32 v97, v97, v225
  v_add_f32 v101, v101, v233
  v_add_f32 v98, v98, v226
  v_add_f32 v102, v102, v234
  v_add_f32 v99, v99, v227
  v_add_f32 v103, v103, v235
  ds_write_b128 v79, v[188:191]
  v_cvt_pk_bf16_f32 v168, v96, v97
  v_cvt_pk_bf16_f32 v169, v98, v99
  v_cvt_pk_bf16_f32 v170, v100, v101
  v_cvt_pk_bf16_f32 v171, v102, v103
  v_mul_f32 v220, v140, v152
  v_mul_f32 v221, v140, v153
  v_mul_f32 v222, v140, v154
  v_mul_f32 v223, v140, v155
  v_mul_f32 v228, v140, v160
  v_mul_f32 v229, v140, v161
  v_mul_f32 v230, v140, v162
  v_mul_f32 v231, v140, v163
  v_mfma_f32_16x16x32_bf16 v[208:211], v[168:171], v[184:187], 0
  v_fma_f32 v112, v112, v148, v220
  v_fma_f32 v113, v113, v149, v221
  v_fma_f32 v114, v114, v150, v222
  v_fma_f32 v115, v115, v151, v223
  v_fma_f32 v116, v116, v156, v228
  v_fma_f32 v117, v117, v157, v229
  v_fma_f32 v118, v118, v158, v230
  v_fma_f32 v119, v119, v159, v231
  v_cvt_pk_bf16_f32 v176, v112, v113
  v_cvt_pk_bf16_f32 v177, v114, v115
  v_cvt_pk_bf16_f32 v178, v116, v117
  v_cvt_pk_bf16_f32 v179, v118, v119
  s_nop 1
  v_mfma_f32_16x16x32_bf16 v[200:203], v[180:183], v[176:179], 0
  v_mfma_f32_16x16x32_bf16 v[192:195], v[168:171], v[176:179], 0
  v_cndmask_b32 v204, v204, v208, s[94:95]
  v_cndmask_b32 v205, v205, v209, s[94:95]
  v_cndmask_b32 v206, v206, v210, s[94:95]
  v_cndmask_b32 v207, v207, v211, s[94:95]
  ds_write_b128 v80, v[204:207] offset:2048
  s_nop 1
  v_cndmask_b32 v196, v196, v200, s[92:93]
  v_cndmask_b32 v197, v197, v201, s[92:93]
  v_cndmask_b32 v198, v198, v202, s[92:93]
  v_cndmask_b32 v199, v199, v203, s[92:93]
  ds_write_b128 v79, v[196:199] offset:3072
  ds_write_b128 v80, v[212:215] offset:3584
  ds_write_b128 v79, v[192:195] offset:1024
  s_mov_b64 exec, 1
  ds_add_u32 v12, v13 offset:12
  s_mov_b64 exec, -1
  s_waitcnt lgkmcnt(0)
  s_mov_b32 s0, 0x1000000
L_lwkvr:
  ds_read_b32 v15, v12 offset:12
  s_sub_u32 s0, s0, 1
  s_cselect_b32 s1, 0, 4
  s_waitcnt lgkmcnt(0)
  v_readfirstlane_b32 s79, v15
  s_nop 0
  s_cmp_lt_u32 s79, s1
  s_cbranch_scc1 L_lwkvr
  ds_read2st64_b32 v[88:89], v81 offset0:0 offset1:1
  ds_read2st64_b32 v[90:91], v81 offset0:2 offset1:3
  ds_read2st64_b32 v[92:93], v81 offset0:20 offset1:21
  ds_read2st64_b32 v[94:95], v81 offset0:22 offset1:23
  ds_read2st64_b32 v[96:97], v81 offset0:40 offset1:41
  ds_read2st64_b32 v[98:99], v81 offset0:42 offset1:43
  ds_read2st64_b32 v[100:101], v81 offset0:60 offset1:61
  ds_read2st64_b32 v[102:103], v81 offset0:62 offset1:63
  s_waitcnt lgkmcnt(5)
  v_pk_add_f32 v[88:89], v[88:89], v[92:93]
  s_waitcnt lgkmcnt(1)
  v_pk_add_f32 v[96:97], v[96:97], v[100:101]
  v_pk_add_f32 v[90:91], v[90:91], v[94:95]
  s_waitcnt lgkmcnt(0)
  v_pk_add_f32 v[98:99], v[98:99], v[102:103]
  v_pk_add_f32 v[88:89], v[88:89], v[96:97]
  buffer_atomic_add_f32 v88, v82, s[52:55], 0 offen offset:0
  buffer_atomic_add_f32 v89, v82, s[52:55], 0 offen offset:256
  v_pk_add_f32 v[90:91], v[90:91], v[98:99]
  buffer_atomic_add_f32 v90, v82, s[52:55], 0 offen offset:512
  buffer_atomic_add_f32 v91, v82, s[52:55], 0 offen offset:768
  s_and_b32 s77, s2, 7
  s_lshl_b32 s94, s77, 7
  s_add_u32 s94, s94, 84992
  s_mov_b32 s95, 0
  s_cmp_lg_u32 s26, 4
  s_cbranch_scc1 L_w0_n
  s_atomic_add s95, s[24:25], s94 glc
L_w0_n:
  s_lshl_b32 s78, s80, 10
  s_mul_i32 s76, s80, 20480
  s_sub_u32 s76, s87, s76
  s_mul_i32 s77, s31, 160
  s_sub_u32 s77, 81920, s77
  s_add_u32 s32, s4, s76
  s_addc_u32 s33, s5, 0
  s_mov_b32 s34, s77
  s_mov_b32 s35, 0x20000
  s_lshl_b32 s1, s28, 7
  s_add_u32 s1, s1, 65536
  s_mov_b64 exec, 1
  s_waitcnt vmcnt(0)
  ds_add_rtn_u32 v15, v12, v13 offset:16
  s_mov_b64 exec, -1
  s_waitcnt lgkmcnt(0)
  v_readfirstlane_b32 s79, v15
  s_nop 0
  s_cmp_lg_u32 s79, 3
  s_cbranch_scc1 L_lsA
  s_atomic_add s3, s[24:25], s1
L_lsA:
  s_setprio 0
  buffer_load_dwordx4 v[36:39], v68, s[48:51], s10 offen nt
  s_add_u32 s10, s10, s11
  buffer_load_dwordx4 v[40:43], v68, s[48:51], s10 offen nt
  s_add_u32 s10, s10, s11
  buffer_load_dwordx4 v[44:47], v68, s[48:51], s10 offen nt
  s_add_u32 s10, s10, s11
  buffer_load_dwordx4 v[48:51], v68, s[48:51], s10 offen nt
  s_lshl_b32 s96, s80, 8
  s_xor_b32 s77, s2, 0xe0
  s_add_u32 s96, s96, s77
  s_add_u32 s77, s96, 484
  s_mul_i32 s10, s77, 2428
  s_lshr_b32 s10, s10, 16
  s_mul_i32 s10, s10, 107136
  s_lshl_b32 s77, s77, 7
  s_add_u32 s10, s10, s77
  s_cmp_ge_u32 s96, 56
  s_cselect_b32 s10, 0x1000000, s10
  buffer_load_dwordx4 v[52:55], v69, s[44:47], s10 offen nt
  s_add_u32 s10, s10, 27648
  buffer_load_dwordx4 v[56:59], v69, s[44:47], s10 offen nt
  s_add_u32 s10, s10, 27648
  buffer_load_dwordx4 v[60:63], v69, s[44:47], s10 offen nt
  s_add_u32 s10, s10, 27648
  buffer_load_dwordx4 v[64:67], v69, s[44:47], s10 offen nt
  s_mul_i32 s72, s80, 5120
  s_mul_i32 s73, s80, 40960
  s_mul_i32 s76, s31, 5120
  s_add_u32 s73, s73, s76
  s_add_u32 s73, s73, 23068672
  s_cmp_ge_u32 s80, 2
  s_cselect_b32 s74, 819200, 0
  s_sub_u32 s74, s73, s74
  v_add_u32 v87, 3072, v2
  s_xor_b32 s90, s28, 1
  s_lshl_b32 s90, s90, 7
  s_add_u32 s90, s90, 65536
  s_mov_b32 s91, 0
  s_cmp_lg_u32 s26, 7
  s_cselect_b32 s92, 1, 0
  v_mov_b32 v21, 4
  s_cmp_lg_u32 s26, 4
  s_cbranch_scc1 L_w0_o
  s_cmp_ge_u32 s95, 100
  s_cbranch_scc1 L_w0_k
  s_waitcnt lgkmcnt(0)
  s_mov_b32 s79, 0x400000
L_sW_p:
  s_mov_b32 s0, 0
  s_atomic_add s0, s[24:25], s94 glc
  s_sub_u32 s79, s79, 1
  s_cselect_b32 s1, 0, 100
  s_waitcnt lgkmcnt(0)
  s_cmp_ge_u32 s0, s1
  s_cbranch_scc1 L_sW_d
  s_sleep 2
  s_branch L_sW_p
L_sW_d:
L_w0_k:
  ds_write_b32 v12, v21 offset:28
  s_branch L_w0_j
L_w0_o:
  s_waitcnt lgkmcnt(0)
  s_mov_b32 s0, 0x1000000
L_lww0:
  ds_read_b32 v15, v12 offset:28
  s_sub_u32 s0, s0, 1
  s_cselect_b32 s1, 0, 4
  s_waitcnt lgkmcnt(0)
  v_readfirstlane_b32 s79, v15
  s_nop 0
  s_cmp_lt_u32 s79, s1
  s_cbranch_scc1 L_lww0
L_w0_j:
  s_add_u32 m0, s72, 20480
  s_add_u32 s76, s73, 573440
  buffer_load_dwordx4 v2, s[52:55], s76 offen offset:0 sc1 lds
  buffer_load_dwordx4 v2, s[52:55], s76 offen offset:1024 sc1 lds
  buffer_load_dwordx4 v2, s[52:55], s76 offen offset:2048 sc1 lds
  buffer_load_dwordx4 v2, s[52:55], s76 offen offset:3072 sc1 lds
  s_add_u32 m0, s72, 23552
  s_nop 0
  buffer_load_dwordx4 v87, s[52:55], s76 offen offset:1024 sc1 lds
  s_waitcnt vmcnt(5)
  s_add_u32 m0, s72, 40960
  s_add_u32 s76, s74, 737280
  buffer_load_dwordx4 v2, s[52:55], s76 offen offset:0 sc1 lds
  buffer_load_dwordx4 v2, s[52:55], s76 offen offset:1024 sc1 lds
  buffer_load_dwordx4 v2, s[52:55], s76 offen offset:2048 sc1 lds
  buffer_load_dwordx4 v2, s[52:55], s76 offen offset:3072 sc1 lds
  s_add_u32 m0, s72, 44032
  s_nop 0
  buffer_load_dwordx4 v87, s[52:55], s76 offen offset:1024 sc1 lds
  s_waitcnt vmcnt(5)
  s_waitcnt lgkmcnt(0)
  s_mov_b32 s0, 0x1000000
L_lwdra:
  ds_read_b32 v15, v12 offset:16
  s_sub_u32 s0, s0, 1
  s_cselect_b32 s1, 0, 4
  s_waitcnt lgkmcnt(0)
  v_readfirstlane_b32 s79, v15
  s_nop 0
  s_cmp_lt_u32 s79, s1
  s_cbranch_scc1 L_lwdra
  s_add_u32 m0, s72, 0
  s_add_u32 s76, s73, 409600
  buffer_load_dwordx4 v2, s[52:55], s76 offen offset:0 sc1 lds
  buffer_load_dwordx4 v2, s[52:55], s76 offen offset:1024 sc1 lds
  buffer_load_dwordx4 v2, s[52:55], s76 offen offset:2048 sc1 lds
  buffer_load_dwordx4 v2, s[52:55], s76 offen offset:3072 sc1 lds
  s_add_u32 m0, s72, 3072
  s_nop 0
  buffer_load_dwordx4 v87, s[52:55], s76 offen offset:1024 sc1 lds
  s_waitcnt vmcnt(5)
  s_waitcnt lgkmcnt(0)
  s_mov_b32 s0, 0x1000000
L_lwpb:
  ds_read_b32 v15, v12 offset:24
  s_sub_u32 s0, s0, 1
  s_cselect_b32 s1, 0, 4
  s_waitcnt lgkmcnt(0)
  v_readfirstlane_b32 s79, v15
  s_nop 0
  s_cmp_lt_u32 s79, s1
  s_cbranch_scc1 L_lwpb
  s_add_u32 m0, s72, 61440
  s_add_u32 s76, s73, 81920
  buffer_load_dwordx4 v2, s[52:55], s76 offen offset:0 sc1 lds
  buffer_load_dwordx4 v2, s[52:55], s76 offen offset:1024 sc1 lds
  buffer_load_dwordx4 v2, s[52:55], s76 offen offset:2048 sc1 lds
  buffer_load_dwordx4 v2, s[52:55], s76 offen offset:3072 sc1 lds
  s_add_u32 m0, s72, 64512
  s_nop 0
  buffer_load_dwordx4 v87, s[52:55], s76 offen offset:1024 sc1 lds
  s_waitcnt vmcnt(5)
  s_cmp_lg_u32 s92, 0
  s_cbranch_scc1 L_pa0
  s_waitcnt lgkmcnt(0)
  s_cmp_lt_u32 s91, 16
  s_cbranch_scc1 L_pq0
  ds_write_b32 v12, v21 offset:32
  s_mov_b32 s92, 1
  s_branch L_pa0
L_pq0:
  s_mov_b32 s91, 0
  s_atomic_add s91, s[24:25], s90 glc
L_pa0:
  s_add_u32 m0, s72, 81920
  s_add_u32 s76, s73, 245760
  buffer_load_dwordx4 v2, s[52:55], s76 offen offset:0 sc1 lds
  buffer_load_dwordx4 v2, s[52:55], s76 offen offset:1024 sc1 lds
  buffer_load_dwordx4 v2, s[52:55], s76 offen offset:2048 sc1 lds
  buffer_load_dwordx4 v2, s[52:55], s76 offen offset:3072 sc1 lds
  s_add_u32 m0, s72, 84992
  s_nop 0
  buffer_load_dwordx4 v87, s[52:55], s76 offen offset:1024 sc1 lds
  s_waitcnt vmcnt(5)
  s_add_u32 m0, s78, 106496
  s_nop 0
  buffer_load_dwordx4 v84, s[32:35], 0 offen lds
  s_add_u32 m0, s78, 110592
  s_nop 0
  buffer_load_dwordx4 v85, s[32:35], 0 offen lds
  s_add_u32 m0, s78, 114688
  s_nop 0
  buffer_load_dwordx4 v86, s[32:35], 0 offen lds
  s_cmp_lg_u32 s92, 0
  s_cbranch_scc1 L_pa1
  s_waitcnt lgkmcnt(0)
  s_cmp_ge_u32 s91, 16
  s_cbranch_scc1 L_paf
  s_waitcnt lgkmcnt(0)
  s_mov_b32 s79, 0x400000
L_sA_p:
  s_mov_b32 s0, 0
  s_atomic_add s0, s[24:25], s90 glc
  s_sub_u32 s79, s79, 1
  s_cselect_b32 s1, 0, 16
  s_waitcnt lgkmcnt(0)
  s_cmp_ge_u32 s0, s1
  s_cbranch_scc1 L_sA_d
  s_sleep 2
  s_branch L_sA_p
L_sA_d:
L_paf:
  ds_write_b32 v12, v21 offset:32
L_pa1:
  s_mov_b64 exec, 1
  ds_add_u32 v12, v13 offset:36
  s_mov_b64 exec, -1
  ds_write_b128 v70, v[36:39] offset:0
  ds_write_b128 v70, v[40:43] offset:1024
  ds_read_b64_tr_b16 v[148:149], v71 offset:0
  ds_read_b64_tr_b16 v[152:153], v71 offset:32
  ds_read_b64_tr_b16 v[156:157], v71 offset:64
  ds_read_b64_tr_b16 v[160:161], v71 offset:96
  ds_write_b128 v70, v[44:47] offset:0
  ds_write_b128 v70, v[48:51] offset:1024
  ds_read_b64_tr_b16 v[150:151], v71 offset:0
  ds_read_b64_tr_b16 v[154:155], v71 offset:32
  ds_read_b64_tr_b16 v[158:159], v71 offset:64
  ds_read_b64_tr_b16 v[162:163], v71 offset:96
  s_waitcnt lgkmcnt(3)
  buffer_store_dwordx4 v[148:151], v2, s[52:55], s100 offen offset:0 sc1
  s_waitcnt lgkmcnt(2)
  buffer_store_dwordx4 v[152:155], v2, s[52:55], s100 offen offset:1024 sc1
  s_waitcnt lgkmcnt(1)
  buffer_store_dwordx4 v[156:159], v2, s[52:55], s100 offen offset:2048 sc1
  s_waitcnt lgkmcnt(0)
  buffer_store_dwordx4 v[160:163], v2, s[52:55], s100 offen offset:3072 sc1
  s_cmp_ge_u32 s96, 56
  s_cbranch_scc1 L_pk2b
  s_lshl_b32 s76, s96, 12
  s_add_u32 s76, s76, 22020096
  ds_write_b128 v70, v[52:55] offset:0
  ds_write_b128 v70, v[56:59] offset:1024
  ds_read_b64_tr_b16 v[148:149], v71 offset:0
  ds_read_b64_tr_b16 v[152:153], v71 offset:32
  ds_read_b64_tr_b16 v[156:157], v71 offset:64
  ds_read_b64_tr_b16 v[160:161], v71 offset:96
  ds_write_b128 v70, v[60:63] offset:0
  ds_write_b128 v70, v[64:67] offset:1024
  ds_read_b64_tr_b16 v[150:151], v71 offset:0
  ds_read_b64_tr_b16 v[154:155], v71 offset:32
  ds_read_b64_tr_b16 v[158:159], v71 offset:64
  ds_read_b64_tr_b16 v[162:163], v71 offset:96
  s_waitcnt lgkmcnt(0)
  buffer_store_dwordx4 v[148:151], v2, s[52:55], s76 offen offset:0 sc1
  s_waitcnt lgkmcnt(0)
  buffer_store_dwordx4 v[152:155], v2, s[52:55], s76 offen offset:1024 sc1
  s_waitcnt lgkmcnt(0)
  buffer_store_dwordx4 v[156:159], v2, s[52:55], s76 offen offset:2048 sc1
  s_waitcnt lgkmcnt(0)
  buffer_store_dwordx4 v[160:163], v2, s[52:55], s76 offen offset:3072 sc1
L_pk2b:
  s_waitcnt lgkmcnt(0)
  s_mov_b32 s0, 0x1000000
L_lwh1:
  ds_read_b32 v15, v12 offset:36
  s_sub_u32 s0, s0, 1
  s_cselect_b32 s1, 0, 4
  s_waitcnt lgkmcnt(0)
  v_readfirstlane_b32 s79, v15
  s_nop 0
  s_cmp_lt_u32 s79, s1
  s_cbranch_scc1 L_lwh1
  v_lshrrev_b32 v20, 4, v1
  s_xor_b32 s76, s81, 1
  s_mul_i32 s76, s76, 51200
  s_lshl_b32 s77, s84, 5
  s_add_u32 s77, s77, s76
  v_add_u32 v252, s77, v2
  s_lshl_b32 s77, s85, 5
  s_add_u32 s77, s77, s76
  v_add_u32 v253, s77, v2
  s_lshl_b32 s77, s86, 5
  s_add_u32 s77, s77, s76
  v_add_u32 v254, s77, v2
  s_movk_i32 s79, 1024
  s_mul_i32 s77, s80, 3072
  s_add_u32 s77, s77, 38912
  s_add_u32 s78, s77, s76
  v_add_u32 v8, s78, v2
  s_sub_u32 s78, 51200, s76
  s_add_u32 s78, s78, s77
  v_add_u32 v9, s78, v2
  v_lshlrev_b32 v255, 3, v1
  v_mul_u32_u24 v10, 1024, v20
  v_add3_u32 v10, v10, v2, s79
  v_and_b32 v18, 15, v1
  v_mul_u32_u24 v18, 160, v18
  v_lshl_add_u32 v18, v20, 3, v18
  s_mul_i32 s76, s80, 2560
  s_add_u32 s76, s76, 106496
  s_add_u32 s77, s76, s84
  v_add_u32 v55, s77, v18
  s_add_u32 s77, s76, s86
  v_add_u32 v56, s77, v18
  ds_read_b128 v[92:95], v252 offset:0
  ds_read_b128 v[96:99], v252 offset:1024
  ds_read_b128 v[100:103], v253 offset:0
  ds_read_b128 v[104:107], v253 offset:1024
  ds_read_b128 v[108:111], v254 offset:0
  ds_read_b128 v[112:115], v252 offset:5120
  ds_read_b128 v[116:119], v252 offset:6144
  ds_read_b128 v[120:123], v253 offset:5120
  ds_read_b128 v[124:127], v253 offset:6144
  ds_read_b128 v[128:131], v254 offset:5120
  ds_read_b128 v[132:135], v252 offset:10240
  ds_read_b128 v[136:139], v252 offset:11264
  ds_read_b128 v[140:143], v253 offset:10240
  ds_read_b128 v[144:147], v253 offset:11264
  ds_read_b128 v[148:151], v254 offset:10240
  ds_read_b128 v[152:155], v252 offset:15360
  ds_read_b128 v[156:159], v252 offset:16384
  ds_read_b128 v[160:163], v253 offset:15360
  ds_read_b128 v[164:167], v253 offset:16384
  ds_read_b128 v[168:171], v254 offset:15360
  ds_read_b128 v[172:175], v252 offset:20480
  ds_read_b128 v[176:179], v252 offset:21504
  ds_read_b128 v[180:183], v253 offset:20480
  ds_read_b128 v[184:187], v253 offset:21504
  ds_read_b128 v[188:191], v254 offset:20480
  ds_read_b128 v[192:195], v252 offset:25600
  ds_read_b128 v[196:199], v252 offset:26624
  ds_read_b128 v[200:203], v253 offset:25600
  ds_read_b128 v[204:207], v253 offset:26624
  ds_read_b128 v[208:211], v254 offset:25600
  ds_read_b128 v[212:215], v252 offset:30720
  ds_read_b128 v[216:219], v252 offset:31744
  ds_read_b128 v[220:223], v253 offset:30720
  ds_read_b128 v[224:227], v253 offset:31744
  ds_read_b128 v[228:231], v254 offset:30720
  ds_read_b128 v[232:235], v252 offset:35840
  ds_read_b128 v[236:239], v252 offset:36864
  ds_read_b128 v[240:243], v253 offset:35840
  ds_read_b128 v[244:247], v253 offset:36864
  ds_read_b128 v[248:251], v254 offset:35840
  s_lshl_b32 s74, s83, 4
  s_lshl_b32 s75, s81, 3
  s_add_u32 s74, s74, s75
  s_mul_i32 s74, s74, 1280
  s_add_u32 s74, s74, 1048576
  s_mul_i32 s100, s28, 7
  s_mul_i32 s76, s28, 6
  s_add_u32 s76, s76, 12
  s_cmp_lt_u32 s28, 12
  s_cselect_b32 s100, s100, s76
  s_add_u32 s10, s100, s26
  s_lshl_b32 s10, s10, 10
  s_add_u32 s10, s10, 20037632
  s_and_b32 s101, s100, 1
  s_lshl_b32 s76, s100, 5
  s_sub_u32 s78, 3456, s76
  s_add_u32 s64, s14, s76
  s_addc_u32 s65, s15, 0
  s_mov_b32 s66, s78
  s_mov_b32 s67, 0x20000
  s_mul_i32 s36, s31, 5
  s_add_u32 s36, s36, 1
  s_lshr_b32 s36, s36, 1
  s_mul_i32 s37, s83, 20
  s_add_u32 s36, s36, s37
  s_cmp_eq_u32 s88, 0
  s_cselect_b32 s37, 2, -1
  s_add_u32 s37, s37, s36
  s_lshl_b32 s37, s37, 10
  s_lshl_b32 s38, s88, 9
  s_add_u32 s37, s37, s38
  s_add_u32 s37, s37, 5242880
  s_cmp_lg_u32 s81, 0
  s_cselect_b32 s37, 33554432, s37
  s_cselect_b32 s7, 0, 1.0
  s_add_u32 s36, s36, s81
  s_lshl_b32 s36, s36, 10
  s_add_u32 s36, s36, 5242880
  s_lshl_b32 s38, s83, 3
  s_add_u32 s38, s38, s31
  s_lshl_b32 s38, s38, 8
  s_lshl_b32 s75, s81, 7
  s_add_u32 s38, s38, s75
  s_add_u32 s38, s38, 8388608
  s_mul_i32 s39, s31, 5120
  s_mul_i32 s75, s26, 40960
  s_add_u32 s39, s39, s75
  s_add_u32 s39, s39, 17825792
  s_mul_i32 s11, s26, 5120
  s_lshl_b32 s48, s101, 5
  s_lshl_b32 s78, s80, 6
  s_add_u32 s48, s48, s78
  s_cmp_eq_u32 s48, 224
  s_cselect_b32 s48, 0, s48
  s_lshl_b32 s51, s48, 5
  s_lshl_b32 s44, s27, 3
  s_lshl_b32 s78, s81, 2
  s_add_u32 s44, s44, s78
  s_mul_i32 s45, s44, 54
  s_mul_i32 s44, s44, 20
  s_add_u32 s44, s44, s80
  s_lshl_b32 s44, s44, 10
  s_add_u32 s44, s44, 5242880
  s_mul_i32 s46, s81, 20480
  s_lshl_b32 s78, s80, 10
  s_add_u32 s46, s46, s78
  s_lshl_b32 s78, s100, 5
  s_add_u32 s78, s78, s48
  s_lshr_b32 s79, s78, 6
  s_add_u32 s45, s45, s79
  s_lshl_b32 s45, s45, 10
  s_bfe_u32 s79, s78, 0x10005
  s_lshl_b32 s79, s79, 9
  s_add_u32 s45, s45, s79
  s_add_u32 s45, s45, 9437184
  s_cmp_ge_u32 s28, 12
  s_cselect_b32 s78, 33554432, s45
  s_cmp_eq_u32 s80, 3
  s_cselect_b32 s45, s78, s45
  s_lshl_b32 s47, s27, 3
  s_add_u32 s47, s47, s26
  s_lshl_b32 s47, s47, 11
  s_add_u32 s47, s47, 8388608
  s_lshl_b32 s49, s26, 7
  s_add_u32 s49, s49, 40960
  s_lshl_b32 s50, s81, 9
  s_add_u32 s50, s50, 40960
  s_waitcnt vmcnt(0)
  s_barrier
  ds_read_b64 v[24:25], v55
  ds_read_b64 v[26:27], v55 offset:32
  ds_read_b64 v[28:29], v56
  s_waitcnt lgkmcnt(2)
  v_lshlrev_b32 v32, 16, v24
  v_and_b32 v33, 0xffff0000, v24
  v_lshlrev_b32 v34, 16, v25
  v_and_b32 v35, 0xffff0000, v25
  s_waitcnt lgkmcnt(1)
  v_lshlrev_b32 v36, 16, v26
  v_and_b32 v37, 0xffff0000, v26
  v_lshlrev_b32 v38, 16, v27
  v_and_b32 v39, 0xffff0000, v27
  s_waitcnt lgkmcnt(0)
  v_lshlrev_b32 v48, 16, v28
  v_and_b32 v49, 0xffff0000, v28
  v_lshlrev_b32 v50, 16, v29
  v_and_b32 v51, 0xffff0000, v29
  v_mul_f32 v48, s7, v48
  v_mul_f32 v49, s7, v49
  v_mul_f32 v50, s7, v50
  v_mul_f32 v51, s7, v51
  s_cmp_lg_u32 s26, 6
  s_cbranch_scc1 L_pkd
  s_lshl_b32 s76, s27, 7
  s_add_u32 s76, s76, 81920
  s_waitcnt lgkmcnt(0)
  s_mov_b32 s0, 1
  s_atomic_add s0, s[24:25], s76 glc
  s_waitcnt lgkmcnt(0)
  s_cmp_lg_u32 s0, 15
  s_cbranch_scc1 L_pkd
  v_lshlrev_b32 v16, 7, v1
  s_mov_b32 s76, 83968
  s_mov_b64 exec, 0xff
  buffer_atomic_add v13, v16, s[52:55], s76 offen sc1
  s_mov_b64 exec, -1
L_pkd:
L_p1join:
  s_cmp_lg_u32 s26, 7
  s_cbranch_scc1 L_sBpol_e
  s_lshl_b32 s76, s29, 7
  s_add_u32 s76, s76, 73728
  s_waitcnt lgkmcnt(0)
  s_mov_b32 s79, 0x400000
L_sB_p:
  s_mov_b32 s0, 0
  s_atomic_add s0, s[24:25], s76 glc
  s_sub_u32 s79, s79, 1
  s_cselect_b32 s1, 0, 16
  s_waitcnt lgkmcnt(0)
  s_cmp_ge_u32 s0, s1
  s_cbranch_scc1 L_sB_d
  s_sleep 2
  s_branch L_sB_p
L_sB_d:
L_sBpol_e:
  s_waitcnt lgkmcnt(0)
  s_barrier
  s_lshl_b32 s76, s26, 11
  s_add_u32 m0, s76, 122880
  s_add_u32 s77, s74, 4096
  buffer_load_dwordx4 v[52:55], v2, s[52:55], s74 offen offset:0 sc1
  buffer_load_dwordx4 v[56:59], v2, s[52:55], s74 offen offset:1280 sc1
  buffer_load_dwordx4 v10, s[52:55], s74 offen sc1 lds
  buffer_load_dwordx4 v10, s[52:55], s77 offen offset:1024 sc1 lds
  buffer_load_dwordx4 v[60:63], v2, s[52:55], s74 offen offset:2560 sc1
  s_add_u32 s74, s74, 3840
  buffer_load_dwordx4 v[64:67], v2, s[52:55], s74 offen offset:0 sc1
  buffer_load_dwordx4 v[68:71], v2, s[52:55], s74 offen offset:1280 sc1
  buffer_load_dwordx4 v[72:75], v2, s[52:55], s74 offen offset:2560 sc1
  s_add_u32 s74, s74, 3840
  buffer_load_dwordx4 v[76:79], v2, s[52:55], s74 offen offset:0 sc1
  buffer_load_dwordx4 v[80:83], v2, s[52:55], s74 offen offset:1280 sc1
  s_add_u32 s76, s76, 122880
  v_lshl_add_u32 v16, v1, 2, s76
  s_waitcnt vmcnt(9)
  v_mfma_f32_16x16x32_bf16 v[32:35], v[92:95], v[52:55], v[32:35]
  v_mfma_f32_16x16x32_bf16 v[36:39], v[96:99], v[52:55], v[36:39]
  v_mfma_f32_16x16x32_bf16 v[40:43], v[100:103], v[52:55], 0
  v_mfma_f32_16x16x32_bf16 v[44:47], v[104:107], v[52:55], 0
  v_mfma_f32_16x16x32_bf16 v[48:51], v[108:111], v[52:55], v[48:51]
  s_waitcnt vmcnt(8)
  v_mfma_f32_16x16x32_bf16 v[32:35], v[112:115], v[56:59], v[32:35]
  ds_read_b128 v[92:95], v252 offset:40960
  v_mfma_f32_16x16x32_bf16 v[36:39], v[116:119], v[56:59], v[36:39]
  ds_read_b128 v[96:99], v252 offset:41984
  v_mfma_f32_16x16x32_bf16 v[40:43], v[120:123], v[56:59], v[40:43]
  ds_read_b128 v[100:103], v253 offset:40960
  v_mfma_f32_16x16x32_bf16 v[44:47], v[124:127], v[56:59], v[44:47]
  ds_read_b128 v[104:107], v253 offset:41984
  v_mfma_f32_16x16x32_bf16 v[48:51], v[128:131], v[56:59], v[48:51]
  ds_read_b128 v[108:111], v254 offset:40960
  s_waitcnt vmcnt(5)
  v_mfma_f32_16x16x32_bf16 v[32:35], v[132:135], v[60:63], v[32:35]
  ds_read_b128 v[112:115], v252 offset:46080
  v_mfma_f32_16x16x32_bf16 v[36:39], v[136:139], v[60:63], v[36:39]
  ds_read_b128 v[116:119], v252 offset:47104
  v_mfma_f32_16x16x32_bf16 v[40:43], v[140:143], v[60:63], v[40:43]
  ds_read_b128 v[120:123], v253 offset:46080
  v_mfma_f32_16x16x32_bf16 v[44:47], v[144:147], v[60:63], v[44:47]
  ds_read_b128 v[124:127], v253 offset:47104
  v_mfma_f32_16x16x32_bf16 v[48:51], v[148:151], v[60:63], v[48:51]
  ds_read_b128 v[128:131], v254 offset:46080
  s_waitcnt vmcnt(4)
  v_mfma_f32_16x16x32_bf16 v[32:35], v[152:155], v[64:67], v[32:35]
  ds_read2st64_b32 v[84:85], v16 offset0:0 offset1:1
  ds_read2st64_b32 v[86:87], v16 offset0:2 offset1:3
  ds_read2st64_b32 v[88:89], v16 offset0:4 offset1:5
  ds_read2st64_b32 v[90:91], v16 offset0:6 offset1:7
  v_mfma_f32_16x16x32_bf16 v[36:39], v[156:159], v[64:67], v[36:39]
  v_mfma_f32_16x16x32_bf16 v[40:43], v[160:163], v[64:67], v[40:43]
  v_mfma_f32_16x16x32_bf16 v[44:47], v[164:167], v[64:67], v[44:47]
  v_mfma_f32_16x16x32_bf16 v[48:51], v[168:171], v[64:67], v[48:51]
  s_waitcnt lgkmcnt(2)
  v_mfma_f32_16x16x32_bf16 v[32:35], v[212:215], v[84:87], v[32:35]
  v_mfma_f32_16x16x32_bf16 v[36:39], v[216:219], v[84:87], v[36:39]
  v_mfma_f32_16x16x32_bf16 v[40:43], v[220:223], v[84:87], v[40:43]
  v_mfma_f32_16x16x32_bf16 v[44:47], v[224:227], v[84:87], v[44:47]
  v_mfma_f32_16x16x32_bf16 v[48:51], v[228:231], v[84:87], v[48:51]
  s_waitcnt vmcnt(3)
  v_mfma_f32_16x16x32_bf16 v[32:35], v[172:175], v[68:71], v[32:35]
  v_mfma_f32_16x16x32_bf16 v[36:39], v[176:179], v[68:71], v[36:39]
  v_mfma_f32_16x16x32_bf16 v[40:43], v[180:183], v[68:71], v[40:43]
  v_mfma_f32_16x16x32_bf16 v[44:47], v[184:187], v[68:71], v[44:47]
  v_mfma_f32_16x16x32_bf16 v[48:51], v[188:191], v[68:71], v[48:51]
  s_waitcnt vmcnt(2)
  v_mfma_f32_16x16x32_bf16 v[32:35], v[192:195], v[72:75], v[32:35]
  v_mfma_f32_16x16x32_bf16 v[36:39], v[196:199], v[72:75], v[36:39]
  v_mfma_f32_16x16x32_bf16 v[40:43], v[200:203], v[72:75], v[40:43]
  v_mfma_f32_16x16x32_bf16 v[44:47], v[204:207], v[72:75], v[44:47]
  v_mfma_f32_16x16x32_bf16 v[48:51], v[208:211], v[72:75], v[48:51]
  s_cmp_lg_u32 s26, 0
  s_cbranch_scc1 L_sPpol_e
  s_and_b32 s77, s2, 7
  s_lshl_b32 s76, s77, 7
  s_add_u32 s76, s76, 83968
  s_waitcnt lgkmcnt(0)
  s_mov_b32 s79, 0x400000
L_sP_p:
  s_mov_b32 s0, 0
  s_atomic_add s0, s[24:25], s76 glc
  s_sub_u32 s79, s79, 1
  s_cselect_b32 s1, 0, 16
  s_waitcnt lgkmcnt(0)
  s_cmp_ge_u32 s0, s1
  s_cbranch_scc1 L_sP_d
  s_sleep 2
  s_branch L_sP_p
L_sP_d:
L_sPpol_e:
  s_cmp_lg_u32 s26, 7
  s_cselect_b64 vcc, -1, 0
  s_waitcnt vmcnt(0)
  s_waitcnt lgkmcnt(0)
  s_barrier
  v_mfma_f32_16x16x32_bf16 v[32:35], v[92:95], v[76:79], v[32:35]
  s_cbranch_vccz L_w1s0
  s_add_u32 m0, s89, 106496
  s_add_u32 s76, s10, 0
  buffer_load_dwordx4 v2, s[52:55], s76 offen sc1 lds
L_w1s0:
  v_mfma_f32_16x16x32_bf16 v[36:39], v[96:99], v[76:79], v[36:39]
  v_mfma_f32_16x16x32_bf16 v[40:43], v[100:103], v[76:79], v[40:43]
  s_cbranch_vccz L_w1s1
  s_add_u32 m0, s89, 113664
  s_add_u32 s76, s10, 110592
  buffer_load_dwordx4 v2, s[52:55], s76 offen sc1 lds
L_w1s1:
  v_mfma_f32_16x16x32_bf16 v[44:47], v[104:107], v[76:79], v[44:47]
  v_mfma_f32_16x16x32_bf16 v[48:51], v[108:111], v[76:79], v[48:51]
  v_mfma_f32_16x16x32_bf16 v[32:35], v[112:115], v[80:83], v[32:35]
  s_cbranch_vccz L_w1s2
  s_add_u32 m0, s89, 120832
  s_add_u32 s76, s10, 221184
  buffer_load_dwordx4 v2, s[52:55], s76 offen sc1 lds
L_w1s2:
  v_mfma_f32_16x16x32_bf16 v[36:39], v[116:119], v[80:83], v[36:39]
  v_mfma_f32_16x16x32_bf16 v[40:43], v[120:123], v[80:83], v[40:43]
  s_cbranch_vccz L_w1s3
  s_add_u32 m0, s89, 128000
  s_add_u32 s76, s10, 331776
  buffer_load_dwordx4 v2, s[52:55], s76 offen sc1 lds
L_w1s3:
  v_mfma_f32_16x16x32_bf16 v[44:47], v[124:127], v[80:83], v[44:47]
  v_mfma_f32_16x16x32_bf16 v[48:51], v[128:131], v[80:83], v[48:51]
  v_mfma_f32_16x16x32_bf16 v[40:43], v[240:243], v[88:91], v[40:43]
  s_cbranch_vccz L_w1s4
  s_add_u32 m0, s89, 135168
  s_add_u32 s76, s10, 442368
  buffer_load_dwordx4 v2, s[52:55], s76 offen sc1 lds
L_w1s4:
  v_mfma_f32_16x16x32_bf16 v[44:47], v[244:247], v[88:91], v[44:47]
  v_mfma_f32_16x16x32_bf16 v[48:51], v[248:251], v[88:91], v[48:51]
  s_cbranch_vccz L_w1s5
  s_add_u32 m0, s89, 142336
  s_add_u32 s76, s10, 552960
  buffer_load_dwordx4 v2, s[52:55], s76 offen sc1 lds
L_w1s5:
  v_mfma_f32_16x16x32_bf16 v[32:35], v[232:235], v[88:91], v[32:35]
  v_mfma_f32_16x16x32_bf16 v[36:39], v[236:239], v[88:91], v[36:39]
  s_nop 1
  ds_write_b128 v8, v[40:43] offset:0
  s_nop 0
  ds_write_b128 v8, v[44:47] offset:1024
  ds_write_b128 v8, v[48:51] offset:2048
  s_cbranch_vccz L_w1s6
  s_add_u32 m0, s89, 149504
  s_add_u32 s76, s10, 663552
  buffer_load_dwordx4 v2, s[52:55], s76 offen sc1 lds
L_w1s6:
  s_cbranch_vccz L_w1s7
  s_add_u32 m0, s89, 156672
  s_add_u32 s76, s10, 774144
  buffer_load_dwordx4 v2, s[52:55], s76 offen sc1 lds
L_w1s7:
  s_cbranch_vccz L_w1s8
  s_add_u32 m0, s89, 0
  s_add_u32 s76, s10, 884736
  buffer_load_dwordx4 v2, s[52:55], s76 offen sc1 lds
L_w1s8:
  s_waitcnt lgkmcnt(0)
  s_barrier
  ds_read_b128 v[92:95], v9 offset:0
  ds_read_b128 v[96:99], v9 offset:1024
  ds_read_b128 v[100:103], v9 offset:2048
  s_waitcnt lgkmcnt(2)
  v_pk_add_f32 v[32:33], v[32:33], v[92:93]
  v_pk_add_f32 v[34:35], v[34:35], v[94:95]
  v_cvt_pk_bf16_f32 v8, v32, v33
  v_cvt_pk_bf16_f32 v9, v34, v35
  s_waitcnt lgkmcnt(1)
  v_pk_add_f32 v[36:37], v[36:37], v[96:97]
  v_pk_add_f32 v[38:39], v[38:39], v[98:99]
  v_cvt_pk_bf16_f32 v10, v36, v37
  v_cvt_pk_bf16_f32 v11, v38, v39
  buffer_store_dwordx4 v[8:11], v2, s[52:55], s36 offen sc1
  s_waitcnt lgkmcnt(0)
  v_pk_add_f32 v[48:49], v[48:49], v[100:101]
  v_pk_add_f32 v[50:51], v[50:51], v[102:103]
  v_cvt_pk_bf16_f32 v12, v48, v49
  v_cvt_pk_bf16_f32 v13, v50, v51
  buffer_store_dwordx2 v[12:13], v255, s[52:55], s37 offen sc1
  v_lshlrev_b32 v112, 16, v8
  v_and_b32 v113, 0xffff0000, v8
  v_lshlrev_b32 v114, 16, v9
  v_and_b32 v115, 0xffff0000, v9
  v_lshlrev_b32 v116, 16, v10
  v_and_b32 v117, 0xffff0000, v10
  v_lshlrev_b32 v118, 16, v11
  v_and_b32 v119, 0xffff0000, v11
  v_lshlrev_b32 v120, 16, v12
  v_and_b32 v121, 0xffff0000, v12
  v_lshlrev_b32 v122, 16, v13
  v_and_b32 v123, 0xffff0000, v13
  v_pk_add_f32 v[92:93], v[120:121], v[122:123]
  v_pk_mul_f32 v[94:95], v[120:121], v[120:121]
  v_pk_fma_f32 v[94:95], v[122:123], v[122:123], v[94:95]
  v_mul_f32 v92, s7, v92
  v_mul_f32 v93, s7, v93
  v_mul_f32 v94, s7, v94
  v_mul_f32 v95, s7, v95
  v_pk_add_f32 v[92:93], v[92:93], v[112:113]
  v_pk_fma_f32 v[94:95], v[112:113], v[112:113], v[94:95]
  v_pk_add_f32 v[92:93], v[92:93], v[114:115]
  v_pk_fma_f32 v[94:95], v[114:115], v[114:115], v[94:95]
  v_pk_add_f32 v[92:93], v[92:93], v[116:117]
  v_pk_fma_f32 v[94:95], v[116:117], v[116:117], v[94:95]
  v_pk_add_f32 v[92:93], v[92:93], v[118:119]
  v_pk_fma_f32 v[94:95], v[118:119], v[118:119], v[94:95]
  v_add_f32 v96, v92, v93
  v_add_f32 v97, v94, v95
  v_mov_b32 v98, v96
  v_mov_b32 v99, v97
  s_nop 0
  v_permlane32_swap_b32 v96, v98
  v_permlane32_swap_b32 v97, v99
  v_pk_add_f32 v[96:97], v[96:97], v[98:99]
  v_mov_b32 v98, v96
  v_mov_b32 v99, v97
  s_nop 0
  v_permlane16_swap_b32 v96, v98
  v_permlane16_swap_b32 v97, v99
  v_pk_add_f32 v[96:97], v[96:97], v[98:99]
  s_mov_b64 exec, 0xffff
  buffer_store_dwordx2 v[96:97], v255, s[52:55], s38 offen sc1
  s_mov_b64 exec, -1
  v_lshrrev_b32 v16, 4, v1
  v_lshlrev_b32 v16, 3, v16
  buffer_load_dwordx2 v[232:233], v16, s[64:67], s48 offen
  buffer_load_dwordx2 v[234:235], v16, s[64:67], s48 offen offset:32
  v_add_u32 v216, s51, v2
  v_add_u32 v217, 56000, v216
  v_add_u32 v218, 106496, v216
  v_lshlrev_b32 v23, 3, v1
  s_waitcnt vmcnt(5)
  s_barrier
  s_cmp_eq_u32 s26, 7
  s_cbranch_scc1 L_w1b_e
  s_add_u32 m0, s89, 7168
  s_add_u32 s76, s10, 995328
  buffer_load_dwordx4 v2, s[52:55], s76 offen sc1 lds
  s_add_u32 m0, s89, 14336
  s_add_u32 s76, s10, 1105920
  buffer_load_dwordx4 v2, s[52:55], s76 offen sc1 lds
  s_add_u32 m0, s89, 21504
  s_add_u32 s76, s10, 1216512
  buffer_load_dwordx4 v2, s[52:55], s76 offen sc1 lds
  s_add_u32 m0, s89, 28672
  s_add_u32 s76, s10, 1327104
  buffer_load_dwordx4 v2, s[52:55], s76 offen sc1 lds
  s_add_u32 m0, s89, 51200
  s_add_u32 s76, s10, 1437696
  buffer_load_dwordx4 v2, s[52:55], s76 offen sc1 lds
L_w1b_e:
  ds_read_b128 v[24:27], v218 offset:0
  ds_read_b128 v[28:31], v218 offset:1024
  ds_read_b128 v[32:35], v218 offset:7168
  ds_read_b128 v[36:39], v218 offset:8192
  ds_read_b128 v[40:43], v218 offset:14336
  ds_read_b128 v[44:47], v218 offset:15360
  s_waitcnt lgkmcnt(5)
  v_mfma_f32_16x16x32_bf16 v[184:187], v[24:27], v[4:7], 0
  ds_read_b128 v[48:51], v218 offset:21504
  s_waitcnt lgkmcnt(5)
  v_mfma_f32_16x16x32_bf16 v[188:191], v[28:31], v[4:7], 0
  ds_read_b128 v[52:55], v218 offset:22528
  s_waitcnt lgkmcnt(5)
  v_mfma_f32_16x16x32_bf16 v[184:187], v[32:35], v[4:7], v[184:187]
  ds_read_b128 v[56:59], v218 offset:28672
  s_waitcnt lgkmcnt(5)
  v_mfma_f32_16x16x32_bf16 v[188:191], v[36:39], v[4:7], v[188:191]
  ds_read_b128 v[60:63], v218 offset:29696
  s_waitcnt lgkmcnt(5)
  v_mfma_f32_16x16x32_bf16 v[184:187], v[40:43], v[4:7], v[184:187]
  ds_read_b128 v[64:67], v218 offset:35840
  s_waitcnt lgkmcnt(5)
  v_mfma_f32_16x16x32_bf16 v[188:191], v[44:47], v[4:7], v[188:191]
  ds_read_b128 v[68:71], v218 offset:36864
  s_waitcnt lgkmcnt(5)
  v_mfma_f32_16x16x32_bf16 v[184:187], v[48:51], v[4:7], v[184:187]
  ds_read_b128 v[72:75], v218 offset:43008
  s_waitcnt lgkmcnt(5)
  v_mfma_f32_16x16x32_bf16 v[188:191], v[52:55], v[4:7], v[188:191]
  ds_read_b128 v[76:79], v218 offset:44032
  s_waitcnt lgkmcnt(5)
  v_mfma_f32_16x16x32_bf16 v[184:187], v[56:59], v[4:7], v[184:187]
  ds_read_b128 v[80:83], v218 offset:50176
  s_waitcnt lgkmcnt(5)
  v_mfma_f32_16x16x32_bf16 v[188:191], v[60:63], v[4:7], v[188:191]
  ds_read_b128 v[84:87], v218 offset:51200
  s_waitcnt lgkmcnt(5)
  v_mfma_f32_16x16x32_bf16 v[184:187], v[64:67], v[4:7], v[184:187]
  ds_read_b128 v[88:91], v216 offset:0
  s_waitcnt lgkmcnt(5)
  v_mfma_f32_16x16x32_bf16 v[188:191], v[68:71], v[4:7], v[188:191]
  ds_read_b128 v[92:95], v216 offset:1024
  s_waitcnt lgkmcnt(5)
  v_mfma_f32_16x16x32_bf16 v[184:187], v[72:75], v[4:7], v[184:187]
  s_waitcnt lgkmcnt(4)
  v_mfma_f32_16x16x32_bf16 v[188:191], v[76:79], v[4:7], v[188:191]
  s_waitcnt lgkmcnt(3)
  v_mfma_f32_16x16x32_bf16 v[184:187], v[80:83], v[4:7], v[184:187]
  s_waitcnt lgkmcnt(2)
  v_mfma_f32_16x16x32_bf16 v[188:191], v[84:87], v[4:7], v[188:191]
  s_waitcnt lgkmcnt(1)
  v_mfma_f32_16x16x32_bf16 v[184:187], v[88:91], v[4:7], v[184:187]
  s_waitcnt lgkmcnt(0)
  v_mfma_f32_16x16x32_bf16 v[188:191], v[92:95], v[4:7], v[188:191]
  s_cmp_eq_u32 s26, 7
  s_cbranch_scc1 L_w1d_e
  s_waitcnt vmcnt(5)
  s_branch L_w1d_j
L_w1d_e:
  s_lshl_b32 s77, s29, 7
  s_add_u32 s77, s77, 75776
  s_lshl_b32 s76, s27, 7
  s_add_u32 s76, s76, 75776
  s_waitcnt vmcnt(0) lgkmcnt(0)
L_w1d_j:
  s_barrier
  s_cmp_eq_u32 s26, 7
  s_cbranch_scc1 L_w1c_e
  s_add_u32 m0, s89, 58368
  s_add_u32 s76, s10, 1548288
  buffer_load_dwordx4 v2, s[52:55], s76 offen sc1 lds
  s_add_u32 m0, s89, 65536
  s_add_u32 s76, s10, 1658880
  buffer_load_dwordx4 v2, s[52:55], s76 offen sc1 lds
  s_add_u32 m0, s89, 72704
  s_add_u32 s76, s10, 1769472
  buffer_load_dwordx4 v2, s[52:55], s76 offen sc1 lds
  s_add_u32 m0, s89, 79872
  s_add_u32 s76, s10, 1880064
  buffer_load_dwordx4 v2, s[52:55], s76 offen sc1 lds
  s_add_u32 m0, s89, 38912
  s_add_u32 s76, s10, 1990656
  buffer_load_dwordx4 v2, s[52:55], s76 offen sc1 lds
  s_add_u32 m0, s89, 90112
  s_add_u32 s76, s10, 2101248
  buffer_load_dwordx4 v2, s[52:55], s76 offen sc1 lds
  s_waitcnt vmcnt(6)
  s_branch L_w1c_j
L_w1c_e:
  s_atomic_add s3, s[24:25], s77
  s_mov_b32 s79, 0x400000
L_s2_p:
  s_mov_b32 s0, 0
  s_atomic_add s0, s[24:25], s76 glc
  s_sub_u32 s79, s79, 1
  s_cselect_b32 s1, 0, 16
  s_waitcnt lgkmcnt(0)
  s_cmp_ge_u32 s0, s1
  s_cbranch_scc1 L_s2_d
  s_sleep 2
  s_branch L_s2_p
L_s2_d:
L_w1c_j:
  s_barrier
  s_add_u32 m0, s46, 122880
  s_add_u32 s76, s44, 0
  buffer_load_dwordx4 v2, s[52:55], s76 offen sc1 lds
  s_add_u32 m0, s46, 126976
  s_add_u32 s76, s44, 4096
  buffer_load_dwordx4 v2, s[52:55], s76 offen sc1 lds
  buffer_load_dwordx2 v[208:209], v23, s[52:55], s47 offen offset:0 sc1
  buffer_load_dwordx2 v[210:211], v23, s[52:55], s47 offen offset:512 sc1
  buffer_load_dwordx2 v[212:213], v23, s[52:55], s47 offen offset:1024 sc1
  buffer_load_dwordx2 v[214:215], v23, s[52:55], s47 offen offset:1536 sc1
  s_add_u32 m0, s46, 131072
  s_add_u32 s76, s44, 8192
  buffer_load_dwordx4 v2, s[52:55], s76 offen sc1 lds
  s_add_u32 m0, s46, 135168
  s_add_u32 s76, s44, 12288
  buffer_load_dwordx4 v2, s[52:55], s76 offen sc1 lds
  s_add_u32 m0, s46, 139264
  s_add_u32 s76, s44, 16384
  buffer_load_dwordx4 v2, s[52:55], s76 offen sc1 lds
  ds_read_b128 v[96:99], v216 offset:7168
  ds_read_b128 v[100:103], v216 offset:8192
  ds_read_b128 v[104:107], v216 offset:14336
  ds_read_b128 v[108:111], v216 offset:15360
  ds_read_b128 v[112:115], v216 offset:21504
  ds_read_b128 v[116:119], v216 offset:22528
  s_waitcnt lgkmcnt(5)
  v_mfma_f32_16x16x32_bf16 v[184:187], v[96:99], v[4:7], v[184:187]
  ds_read_b128 v[120:123], v216 offset:28672
  s_waitcnt lgkmcnt(5)
  v_mfma_f32_16x16x32_bf16 v[188:191], v[100:103], v[4:7], v[188:191]
  ds_read_b128 v[124:127], v216 offset:29696
  s_waitcnt lgkmcnt(5)
  v_mfma_f32_16x16x32_bf16 v[184:187], v[104:107], v[4:7], v[184:187]
  ds_read_b128 v[128:131], v216 offset:51200
  s_waitcnt lgkmcnt(5)
  v_mfma_f32_16x16x32_bf16 v[188:191], v[108:111], v[4:7], v[188:191]
  ds_read_b128 v[132:135], v216 offset:52224
  s_waitcnt lgkmcnt(5)
  v_mfma_f32_16x16x32_bf16 v[184:187], v[112:115], v[4:7], v[184:187]
  s_waitcnt lgkmcnt(4)
  v_mfma_f32_16x16x32_bf16 v[188:191], v[116:119], v[4:7], v[188:191]
  s_waitcnt lgkmcnt(3)
  v_mfma_f32_16x16x32_bf16 v[184:187], v[120:123], v[4:7], v[184:187]
  s_waitcnt lgkmcnt(2)
  v_mfma_f32_16x16x32_bf16 v[188:191], v[124:127], v[4:7], v[188:191]
  s_waitcnt lgkmcnt(1)
  v_mfma_f32_16x16x32_bf16 v[184:187], v[128:131], v[4:7], v[184:187]
  s_waitcnt lgkmcnt(0)
  v_mfma_f32_16x16x32_bf16 v[188:191], v[132:135], v[4:7], v[188:191]
  v_mov_b32 v252, 0xbdd2d3e8
  v_mov_b32 v253, 0xc0135761
  v_lshlrev_b32 v192, 16, v232
  v_and_b32 v193, 0xffff0000, v232
  v_lshlrev_b32 v194, 16, v233
  v_and_b32 v195, 0xffff0000, v233
  v_lshlrev_b32 v196, 16, v234
  v_and_b32 v197, 0xffff0000, v234
  v_lshlrev_b32 v198, 16, v235
  v_and_b32 v199, 0xffff0000, v235
  v_add_u32 v15, 3072, v2
  v_and_b32 v16, 15, v1
  v_lshl_add_u32 v21, v16, 3, s49
  v_lshl_add_u32 v22, v16, 3, s50
  s_mov_b32 s37, 0x3acccccd
  s_mov_b32 s38, 0x3727c5ac
  s_lshl_b32 s6, s80, 12
  s_add_u32 s6, s6, s44
  s_mul_i32 s78, s81, 20480
  s_add_u32 s78, s78, 81920
  s_waitcnt vmcnt(9)
  s_barrier
  ds_read_b128 v[136:139], v217 offset:2368
  ds_read_b128 v[140:143], v217 offset:3392
  ds_read_b128 v[144:147], v217 offset:9536
  ds_read_b128 v[148:151], v217 offset:10560
  ds_read_b128 v[152:155], v217 offset:16704
  ds_read_b128 v[156:159], v217 offset:17728
  s_waitcnt lgkmcnt(5)
  v_mfma_f32_16x16x32_bf16 v[184:187], v[136:139], v[4:7], v[184:187]
  ds_read_b128 v[160:163], v217 offset:23872
  s_waitcnt lgkmcnt(5)
  v_mfma_f32_16x16x32_bf16 v[188:191], v[140:143], v[4:7], v[188:191]
  ds_read_b128 v[164:167], v217 offset:24896
  s_waitcnt lgkmcnt(5)
  v_mfma_f32_16x16x32_bf16 v[184:187], v[144:147], v[4:7], v[184:187]
  ds_read_b128 v[168:171], v216 offset:38912
  s_waitcnt lgkmcnt(5)
  v_mfma_f32_16x16x32_bf16 v[188:191], v[148:151], v[4:7], v[188:191]
  ds_read_b128 v[172:175], v216 offset:39936
  s_waitcnt lgkmcnt(5)
  v_mfma_f32_16x16x32_bf16 v[184:187], v[152:155], v[4:7], v[184:187]
  ds_read_b128 v[176:179], v217 offset:34112
  s_waitcnt lgkmcnt(5)
  v_mfma_f32_16x16x32_bf16 v[188:191], v[156:159], v[4:7], v[188:191]
  ds_read_b128 v[180:183], v217 offset:35136
  s_waitcnt lgkmcnt(5)
  v_mfma_f32_16x16x32_bf16 v[184:187], v[160:163], v[4:7], v[184:187]
  s_waitcnt lgkmcnt(4)
  v_mfma_f32_16x16x32_bf16 v[188:191], v[164:167], v[4:7], v[188:191]
  s_waitcnt lgkmcnt(3)
  v_mfma_f32_16x16x32_bf16 v[184:187], v[168:171], v[4:7], v[184:187]
  s_waitcnt lgkmcnt(2)
  v_mfma_f32_16x16x32_bf16 v[188:191], v[172:175], v[4:7], v[188:191]
  s_waitcnt lgkmcnt(1)
  v_mfma_f32_16x16x32_bf16 v[184:187], v[176:179], v[4:7], v[184:187]
  s_waitcnt lgkmcnt(0)
  v_mfma_f32_16x16x32_bf16 v[188:191], v[180:183], v[4:7], v[188:191]
  v_add_u32 v4, s78, v2
  v_add_u32 v5, 40960, v4
  v_mov_b32 v7, v23
  v_add_u32 v6, s78, v23
  s_waitcnt vmcnt(8)
  s_waitcnt lgkmcnt(0)
  s_barrier
  s_cmp_lt_u32 s26, 4
  s_cbranch_scc1 L_pr3
  s_setprio 1
L_pr3:
  ds_read_b128 v[216:219], v5 offset:0
  ds_read_b128 v[220:223], v5 offset:1024
  ds_read2st64_b64 v[224:227], v6 offset0:84 offset1:85
  s_waitcnt lgkmcnt(2)
  v_mfma_f32_16x16x32_bf16 v[200:203], v[24:27], v[216:219], 0
  v_mfma_f32_16x16x32_bf16 v[204:207], v[28:31], v[216:219], 0
  ds_read_b128 v[228:231], v5 offset:3072
  s_waitcnt lgkmcnt(2)
  v_mfma_f32_16x16x32_bf16 v[200:203], v[32:35], v[220:223], v[200:203]
  s_add_u32 m0, s11, 81920
  s_add_u32 s7, s6, 20480
  buffer_load_dwordx4 v2, s[52:55], s7 offen offset:0 sc1 lds
  v_mfma_f32_16x16x32_bf16 v[204:207], v[36:39], v[220:223], v[204:207]
  s_waitcnt vmcnt(8)
  s_barrier
  ds_read_b128 v[216:219], v5 offset:4096
  s_waitcnt lgkmcnt(2)
  v_mfma_f32_16x16x32_bf16 v[200:203], v[40:43], v[224:227], v[200:203]
  buffer_load_dwordx4 v2, s[52:55], s7 offen offset:1024 sc1 lds
  v_mfma_f32_16x16x32_bf16 v[204:207], v[44:47], v[224:227], v[204:207]
  ds_read_b128 v[220:223], v5 offset:5120
  s_waitcnt lgkmcnt(2)
  v_mfma_f32_16x16x32_bf16 v[200:203], v[48:51], v[228:231], v[200:203]
  buffer_load_dwordx4 v2, s[52:55], s7 offen offset:2048 sc1 lds
  v_mfma_f32_16x16x32_bf16 v[204:207], v[52:55], v[228:231], v[204:207]
  ds_read_b128 v[224:227], v5 offset:6144
  s_waitcnt vmcnt(8)
  v_pk_add_f32 v[208:209], v[208:209], v[210:211]
  s_waitcnt lgkmcnt(2)
  v_mfma_f32_16x16x32_bf16 v[200:203], v[56:59], v[216:219], v[200:203]
  s_waitcnt vmcnt(6)
  v_pk_add_f32 v[212:213], v[212:213], v[214:215]
  v_mfma_f32_16x16x32_bf16 v[204:207], v[60:63], v[216:219], v[204:207]
  ds_read2st64_b64 v[228:231], v6 offset0:94 offset1:95
  v_pk_add_f32 v[208:209], v[208:209], v[212:213]
  buffer_load_dwordx4 v2, s[52:55], s7 offen offset:3072 sc1 lds
  v_mov_b32 v210, v208
  s_waitcnt lgkmcnt(2)
  v_mfma_f32_16x16x32_bf16 v[200:203], v[64:67], v[220:223], v[200:203]
  v_mov_b32 v211, v209
  v_mfma_f32_16x16x32_bf16 v[204:207], v[68:71], v[220:223], v[204:207]
  s_waitcnt vmcnt(4)
  s_barrier
  ds_read_b128 v[216:219], v5 offset:8192
  v_permlane32_swap_b32 v208, v210
  s_add_u32 m0, s11, 84992
  s_nop 0
  buffer_load_dwordx4 v15, s[52:55], s7 offen offset:1024 sc1 lds
  v_permlane32_swap_b32 v209, v211
  s_waitcnt lgkmcnt(2)
  v_mfma_f32_16x16x32_bf16 v[200:203], v[72:75], v[224:227], v[200:203]
  v_pk_add_f32 v[208:209], v[208:209], v[210:211]
  v_mfma_f32_16x16x32_bf16 v[204:207], v[76:79], v[224:227], v[204:207]
  ds_read_b128 v[220:223], v5 offset:9216
  v_mov_b32 v210, v208
  s_waitcnt lgkmcnt(2)
  v_mfma_f32_16x16x32_bf16 v[200:203], v[80:83], v[228:231], v[200:203]
  v_mov_b32 v211, v209
  v_mfma_f32_16x16x32_bf16 v[204:207], v[84:87], v[228:231], v[204:207]
  ds_read_b128 v[224:227], v5 offset:10240
  v_permlane16_swap_b32 v208, v210
  s_waitcnt lgkmcnt(2)
  v_mfma_f32_16x16x32_bf16 v[200:203], v[88:91], v[216:219], v[200:203]
  v_permlane16_swap_b32 v209, v211
  v_mfma_f32_16x16x32_bf16 v[204:207], v[92:95], v[216:219], v[204:207]
  ds_read_b128 v[228:231], v5 offset:11264
  v_pk_add_f32 v[208:209], v[208:209], v[210:211]
  s_waitcnt lgkmcnt(2)
  v_mfma_f32_16x16x32_bf16 v[200:203], v[96:99], v[220:223], v[200:203]
  v_mul_f32 v208, s37, v208
  v_mfma_f32_16x16x32_bf16 v[204:207], v[100:103], v[220:223], v[204:207]
  ds_read2st64_b64 v[216:219], v6 offset0:104 offset1:105
  v_mul_f32 v209, s37, v209
  s_waitcnt lgkmcnt(2)
  v_mfma_f32_16x16x32_bf16 v[200:203], v[104:107], v[224:227], v[200:203]
  v_fma_f32 v209, -v208, v208, v209
  v_mfma_f32_16x16x32_bf16 v[204:207], v[108:111], v[224:227], v[204:207]
  ds_read_b128 v[220:223], v5 offset:13312
  v_max_f32 v209, 0, v209
  s_waitcnt lgkmcnt(2)
  v_mfma_f32_16x16x32_bf16 v[200:203], v[112:115], v[228:231], v[200:203]
  v_add_f32 v210, s38, v209
  v_mfma_f32_16x16x32_bf16 v[204:207], v[116:119], v[228:231], v[204:207]
  ds_read_b128 v[224:227], v5 offset:14336
  v_rsq_f32 v210, v210
  s_waitcnt lgkmcnt(2)
  v_mfma_f32_16x16x32_bf16 v[200:203], v[120:123], v[216:219], v[200:203]
  v_mul_f32 v211, v210, v210
  v_mfma_f32_16x16x32_bf16 v[204:207], v[124:127], v[216:219], v[204:207]
  ds_read_b128 v[228:231], v5 offset:15360
  v_fma_f32 v211, v211, v209, s38
  s_waitcnt lgkmcnt(2)
  v_mfma_f32_16x16x32_bf16 v[200:203], v[128:131], v[220:223], v[200:203]
  v_rsq_f32 v211, v211
  v_mfma_f32_16x16x32_bf16 v[204:207], v[132:135], v[220:223], v[204:207]
  ds_read_b128 v[216:219], v5 offset:16384
  v_mul_f32 v212, v210, v211
  s_waitcnt lgkmcnt(2)
  v_mfma_f32_16x16x32_bf16 v[200:203], v[136:139], v[224:227], v[200:203]
  v_mul_f32 v213, -v208, v212
  v_mfma_f32_16x16x32_bf16 v[204:207], v[140:143], v[224:227], v[204:207]
  ds_read2st64_b64 v[220:223], v6 offset0:114 offset1:115
  ds_write_b64 v21, v[212:213]
  s_waitcnt lgkmcnt(3)
  v_mfma_f32_16x16x32_bf16 v[200:203], v[144:147], v[228:231], v[200:203]
  v_mfma_f32_16x16x32_bf16 v[204:207], v[148:151], v[228:231], v[204:207]
  ds_read_b128 v[224:227], v5 offset:18432
  s_waitcnt lgkmcnt(3)
  v_mfma_f32_16x16x32_bf16 v[200:203], v[152:155], v[216:219], v[200:203]
  v_mfma_f32_16x16x32_bf16 v[204:207], v[156:159], v[216:219], v[204:207]
  ds_read_b128 v[228:231], v5 offset:19456
  s_waitcnt lgkmcnt(3)
  v_mfma_f32_16x16x32_bf16 v[200:203], v[160:163], v[220:223], v[200:203]
  v_mfma_f32_16x16x32_bf16 v[204:207], v[164:167], v[220:223], v[204:207]
  s_waitcnt vmcnt(0)
  s_waitcnt lgkmcnt(2)
  s_barrier
  ds_read_b64 v[244:245], v22 offset:0
  ds_read_b64 v[246:247], v22 offset:128
  ds_read_b64 v[248:249], v22 offset:256
  ds_read_b64 v[250:251], v22 offset:384
  ds_read_b128 v[216:219], v4 offset:0
  s_waitcnt lgkmcnt(6)
  v_mfma_f32_16x16x32_bf16 v[200:203], v[168:171], v[224:227], v[200:203]
  v_mfma_f32_16x16x32_bf16 v[204:207], v[172:175], v[224:227], v[204:207]
  ds_read_b128 v[220:223], v4 offset:1024
  s_waitcnt lgkmcnt(6)
  v_mfma_f32_16x16x32_bf16 v[200:203], v[176:179], v[228:231], v[200:203]
  v_mfma_f32_16x16x32_bf16 v[204:207], v[180:183], v[228:231], v[204:207]
  ds_read2st64_b64 v[224:227], v6 offset0:4 offset1:5
  s_waitcnt lgkmcnt(2)
  v_mfma_f32_16x16x32_bf16 v[208:211], v[24:27], v[216:219], 0
  v_mfma_f32_16x16x32_bf16 v[212:215], v[28:31], v[216:219], 0
  ds_read_b128 v[228:231], v4 offset:3072
  s_waitcnt lgkmcnt(2)
  v_mfma_f32_16x16x32_bf16 v[208:211], v[32:35], v[220:223], v[208:211]
  v_mfma_f32_16x16x32_bf16 v[212:215], v[36:39], v[220:223], v[212:215]
  ds_read_b128 v[216:219], v4 offset:4096
  s_barrier
  s_waitcnt lgkmcnt(1)
  v_mfma_f32_16x16x32_bf16 v[208:211], v[40:43], v[224:227], v[208:211]
  v_fma_f32 v232, v184, v245, v192
  v_fma_f32 v233, v185, v245, v193
  s_add_u32 m0, s11, 122880
  s_add_u32 s7, s6, 40960
  buffer_load_dwordx4 v2, s[52:55], s7 offen offset:0 sc1 lds
  v_fma_f32 v234, v186, v245, v194
  v_fma_f32 v235, v187, v245, v195
  v_mfma_f32_16x16x32_bf16 v[212:215], v[44:47], v[224:227], v[212:215]
  ds_read_b128 v[220:223], v4 offset:5120
  v_fma_f32 v236, v188, v245, v196
  v_fma_f32 v237, v189, v245, v197
  v_mfma_f32_16x16x32_bf16 v[208:211], v[48:51], v[228:231], v[208:211]
  v_fma_f32 v238, v190, v245, v198
  buffer_load_dwordx4 v2, s[52:55], s7 offen offset:1024 sc1 lds
  v_fma_f32 v239, v191, v245, v199
  v_fma_f32 v200, v200, v244, v232
  v_mfma_f32_16x16x32_bf16 v[212:215], v[52:55], v[228:231], v[212:215]
  ds_read_b128 v[224:227], v4 offset:6144
  v_fma_f32 v201, v201, v244, v233
  v_fma_f32 v202, v202, v244, v234
  s_waitcnt lgkmcnt(1)
  v_mfma_f32_16x16x32_bf16 v[208:211], v[56:59], v[216:219], v[208:211]
  v_fma_f32 v203, v203, v244, v235
  v_fma_f32 v204, v204, v244, v236
  buffer_load_dwordx4 v2, s[52:55], s7 offen offset:2048 sc1 lds
  v_fma_f32 v205, v205, v244, v237
  v_mfma_f32_16x16x32_bf16 v[212:215], v[60:63], v[216:219], v[212:215]
  ds_read2st64_b64 v[228:231], v6 offset0:14 offset1:15
  v_fma_f32 v206, v206, v244, v238
  v_fma_f32 v207, v207, v244, v239
  v_mfma_f32_16x16x32_bf16 v[208:211], v[64:67], v[220:223], v[208:211]
  v_mul_f32 v232, v200, v200
  v_mul_f32 v233, v201, v201
  buffer_load_dwordx4 v2, s[52:55], s7 offen offset:3072 sc1 lds
  v_mul_f32 v234, v202, v202
  v_mul_f32 v235, v203, v203
  v_mfma_f32_16x16x32_bf16 v[212:215], v[68:71], v[220:223], v[212:215]
  ds_read_b128 v[216:219], v4 offset:8192
  v_mul_f32 v236, v204, v204
  s_waitcnt lgkmcnt(1)
  v_mfma_f32_16x16x32_bf16 v[208:211], v[72:75], v[224:227], v[208:211]
  v_mul_f32 v237, v205, v205
  v_mul_f32 v238, v206, v206
  s_add_u32 m0, s11, 125952
  s_nop 0
  buffer_load_dwordx4 v15, s[52:55], s7 offen offset:1024 sc1 lds
  v_mul_f32 v239, v207, v207
  v_fma_f32 v232, v232, v252, v253
  v_mfma_f32_16x16x32_bf16 v[212:215], v[76:79], v[224:227], v[212:215]
  ds_read_b128 v[220:223], v4 offset:9216
  v_fma_f32 v233, v233, v252, v253
  v_fma_f32 v234, v234, v252, v253
  v_mfma_f32_16x16x32_bf16 v[208:211], v[80:83], v[228:231], v[208:211]
  v_fma_f32 v235, v235, v252, v253
  v_mfma_f32_16x16x32_bf16 v[212:215], v[84:87], v[228:231], v[212:215]
  ds_read_b128 v[224:227], v4 offset:10240
  v_fma_f32 v236, v236, v252, v253
  v_fma_f32 v237, v237, v252, v253
  s_add_u32 m0, s11, 0
  s_add_u32 s7, s39, 0
  buffer_load_dwordx4 v2, s[52:55], s7 offen offset:0 sc1 lds
  v_fma_f32 v238, v238, v252, v253
  v_fma_f32 v239, v239, v252, v253
  s_waitcnt lgkmcnt(1)
  v_mfma_f32_16x16x32_bf16 v[208:211], v[88:91], v[216:219], v[208:211]
  v_mul_f32 v232, v232, v200
  v_mul_f32 v233, v233, v201
  v_mfma_f32_16x16x32_bf16 v[212:215], v[92:95], v[216:219], v[212:215]
  ds_read_b128 v[228:231], v4 offset:11264
  v_mul_f32 v234, v234, v202
  buffer_load_dwordx4 v2, s[52:55], s7 offen offset:1024 sc1 lds
  v_mul_f32 v235, v235, v203
  v_mul_f32 v236, v236, v204
  v_mfma_f32_16x16x32_bf16 v[208:211], v[96:99], v[220:223], v[208:211]
  v_mul_f32 v237, v237, v205
  v_mul_f32 v238, v238, v206
  v_mfma_f32_16x16x32_bf16 v[212:215], v[100:103], v[220:223], v[212:215]
  ds_read2st64_b64 v[216:219], v6 offset0:24 offset1:25
  v_mul_f32 v239, v239, v207
  v_exp_f32 v232, v232
  buffer_load_dwordx4 v2, s[52:55], s7 offen offset:2048 sc1 lds
  v_exp_f32 v233, v233
  s_waitcnt lgkmcnt(1)
  v_mfma_f32_16x16x32_bf16 v[208:211], v[104:107], v[224:227], v[208:211]
  v_exp_f32 v234, v234
  v_exp_f32 v235, v235
  v_mfma_f32_16x16x32_bf16 v[212:215], v[108:111], v[224:227], v[212:215]
  ds_read_b128 v[220:223], v4 offset:13312
  v_exp_f32 v236, v236
  v_exp_f32 v237, v237
  buffer_load_dwordx4 v2, s[52:55], s7 offen offset:3072 sc1 lds
  v_exp_f32 v238, v238
  v_exp_f32 v239, v239
  v_mfma_f32_16x16x32_bf16 v[208:211], v[112:115], v[228:231], v[208:211]
  v_add_f32 v232, 1.0, v232
  v_mfma_f32_16x16x32_bf16 v[212:215], v[116:119], v[228:231], v[212:215]
  ds_read_b128 v[224:227], v4 offset:14336
  v_add_f32 v233, 1.0, v233
  v_add_f32 v234, 1.0, v234
  s_add_u32 m0, s11, 3072
  s_nop 0
  buffer_load_dwordx4 v15, s[52:55], s7 offen offset:1024 sc1 lds
  v_add_f32 v235, 1.0, v235
  v_add_f32 v236, 1.0, v236
  s_waitcnt lgkmcnt(1)
  v_mfma_f32_16x16x32_bf16 v[208:211], v[120:123], v[216:219], v[208:211]
  v_add_f32 v237, 1.0, v237
  v_add_f32 v238, 1.0, v238
  v_mfma_f32_16x16x32_bf16 v[212:215], v[124:127], v[216:219], v[212:215]
  ds_read_b128 v[228:231], v4 offset:15360
  v_add_f32 v239, 1.0, v239
  v_mfma_f32_16x16x32_bf16 v[208:211], v[128:131], v[220:223], v[208:211]
  v_rcp_f32 v232, v232
  v_rcp_f32 v233, v233
  v_mfma_f32_16x16x32_bf16 v[212:215], v[132:135], v[220:223], v[212:215]
  ds_read_b128 v[216:219], v4 offset:16384
  v_rcp_f32 v234, v234
  v_rcp_f32 v235, v235
  s_waitcnt lgkmcnt(1)
  v_mfma_f32_16x16x32_bf16 v[208:211], v[136:139], v[224:227], v[208:211]
  v_rcp_f32 v236, v236
  v_rcp_f32 v237, v237
  v_mfma_f32_16x16x32_bf16 v[212:215], v[140:143], v[224:227], v[212:215]
  ds_read2st64_b64 v[220:223], v6 offset0:34 offset1:35
  v_rcp_f32 v238, v238
  v_mfma_f32_16x16x32_bf16 v[208:211], v[144:147], v[228:231], v[208:211]
  v_rcp_f32 v239, v239
  v_mul_f32 v200, v200, v232
  v_mfma_f32_16x16x32_bf16 v[212:215], v[148:151], v[228:231], v[212:215]
  ds_read_b128 v[224:227], v4 offset:18432
  v_mul_f32 v201, v201, v233
  v_mul_f32 v202, v202, v234
  s_waitcnt lgkmcnt(1)
  v_mfma_f32_16x16x32_bf16 v[208:211], v[152:155], v[216:219], v[208:211]
  v_mul_f32 v203, v203, v235
  v_mul_f32 v204, v204, v236
  v_mfma_f32_16x16x32_bf16 v[212:215], v[156:159], v[216:219], v[212:215]
  ds_read_b128 v[228:231], v4 offset:19456
  v_mul_f32 v205, v205, v237
  v_mfma_f32_16x16x32_bf16 v[208:211], v[160:163], v[220:223], v[208:211]
  v_mul_f32 v206, v206, v238
  v_mul_f32 v207, v207, v239
  v_mfma_f32_16x16x32_bf16 v[212:215], v[164:167], v[220:223], v[212:215]
  s_waitcnt vmcnt(5)
  s_barrier
  ds_read_b128 v[216:219], v5 offset:0
  v_cvt_pk_bf16_f32 v240, v200, v201
  v_cvt_pk_bf16_f32 v241, v202, v203
  s_waitcnt lgkmcnt(2)
  v_mfma_f32_16x16x32_bf16 v[208:211], v[168:171], v[224:227], v[208:211]
  v_cvt_pk_bf16_f32 v242, v204, v205
  v_cvt_pk_bf16_f32 v243, v206, v207
  v_mfma_f32_16x16x32_bf16 v[212:215], v[172:175], v[224:227], v[212:215]
  ds_read_b128 v[220:223], v5 offset:1024
  s_cmp_eq_u32 s80, 3
  s_cbranch_scc1 L_g0s
  buffer_store_dwordx4 v[240:243], v2, s[52:55], s45 offen sc1
  s_branch L_g0b
L_g0s:
  buffer_store_dwordx2 v[240:241], v7, s[52:55], s45 offen sc1
L_g0b:
  s_add_u32 s45, s45, 55296
  s_waitcnt lgkmcnt(2)
  v_mfma_f32_16x16x32_bf16 v[208:211], v[176:179], v[228:231], v[208:211]
  v_mfma_f32_16x16x32_bf16 v[212:215], v[180:183], v[228:231], v[212:215]
  ds_read2st64_b64 v[224:227], v6 offset0:84 offset1:85
  s_waitcnt lgkmcnt(2)
  v_mfma_f32_16x16x32_bf16 v[200:203], v[24:27], v[216:219], 0
  v_mfma_f32_16x16x32_bf16 v[204:207], v[28:31], v[216:219], 0
  ds_read_b128 v[228:231], v5 offset:3072
  s_waitcnt lgkmcnt(2)
  v_mfma_f32_16x16x32_bf16 v[200:203], v[32:35], v[220:223], v[200:203]
  v_mfma_f32_16x16x32_bf16 v[204:207], v[36:39], v[220:223], v[204:207]
  ds_read_b128 v[216:219], v5 offset:4096
  s_barrier
  s_waitcnt lgkmcnt(1)
  v_mfma_f32_16x16x32_bf16 v[200:203], v[40:43], v[224:227], v[200:203]
  v_fma_f32 v232, v184, v247, v192
  v_fma_f32 v233, v185, v247, v193
  s_add_u32 m0, s11, 81920
  s_add_u32 s7, s6, 61440
  buffer_load_dwordx4 v2, s[52:55], s7 offen offset:0 sc1 lds
  v_fma_f32 v234, v186, v247, v194
  v_fma_f32 v235, v187, v247, v195
  v_mfma_f32_16x16x32_bf16 v[204:207], v[44:47], v[224:227], v[204:207]
  ds_read_b128 v[220:223], v5 offset:5120
  v_fma_f32 v236, v188, v247, v196
  v_fma_f32 v237, v189, v247, v197
  v_mfma_f32_16x16x32_bf16 v[200:203], v[48:51], v[228:231], v[200:203]
  v_fma_f32 v238, v190, v247, v198
  buffer_load_dwordx4 v2, s[52:55], s7 offen offset:1024 sc1 lds
  v_fma_f32 v239, v191, v247, v199
  v_fma_f32 v208, v208, v246, v232
  v_mfma_f32_16x16x32_bf16 v[204:207], v[52:55], v[228:231], v[204:207]
  ds_read_b128 v[224:227], v5 offset:6144
  v_fma_f32 v209, v209, v246, v233
  v_fma_f32 v210, v210, v246, v234
  s_waitcnt lgkmcnt(1)
  v_mfma_f32_16x16x32_bf16 v[200:203], v[56:59], v[216:219], v[200:203]
  v_fma_f32 v211, v211, v246, v235
  v_fma_f32 v212, v212, v246, v236
  buffer_load_dwordx4 v2, s[52:55], s7 offen offset:2048 sc1 lds
  v_fma_f32 v213, v213, v246, v237
  v_mfma_f32_16x16x32_bf16 v[204:207], v[60:63], v[216:219], v[204:207]
  ds_read2st64_b64 v[228:231], v6 offset0:94 offset1:95
  v_fma_f32 v214, v214, v246, v238
  v_fma_f32 v215, v215, v246, v239
  v_mfma_f32_16x16x32_bf16 v[200:203], v[64:67], v[220:223], v[200:203]
  v_mul_f32 v232, v208, v208
  v_mul_f32 v233, v209, v209
  buffer_load_dwordx4 v2, s[52:55], s7 offen offset:3072 sc1 lds
  v_mul_f32 v234, v210, v210
  v_mul_f32 v235, v211, v211
  v_mfma_f32_16x16x32_bf16 v[204:207], v[68:71], v[220:223], v[204:207]
  ds_read_b128 v[216:219], v5 offset:8192
  v_mul_f32 v236, v212, v212
  s_waitcnt lgkmcnt(1)
  v_mfma_f32_16x16x32_bf16 v[200:203], v[72:75], v[224:227], v[200:203]
  v_mul_f32 v237, v213, v213
  v_mul_f32 v238, v214, v214
  s_add_u32 m0, s11, 84992
  s_nop 0
  buffer_load_dwordx4 v15, s[52:55], s7 offen offset:1024 sc1 lds
  v_mul_f32 v239, v215, v215
  v_fma_f32 v232, v232, v252, v253
  v_mfma_f32_16x16x32_bf16 v[204:207], v[76:79], v[224:227], v[204:207]
  ds_read_b128 v[220:223], v5 offset:9216
  v_fma_f32 v233, v233, v252, v253
  v_fma_f32 v234, v234, v252, v253
  v_mfma_f32_16x16x32_bf16 v[200:203], v[80:83], v[228:231], v[200:203]
  v_fma_f32 v235, v235, v252, v253
  v_mfma_f32_16x16x32_bf16 v[204:207], v[84:87], v[228:231], v[204:207]
  ds_read_b128 v[224:227], v5 offset:10240
  v_fma_f32 v236, v236, v252, v253
  v_fma_f32 v237, v237, v252, v253
  s_add_u32 m0, s11, 40960
  s_add_u32 s7, s39, 327680
  buffer_load_dwordx4 v2, s[52:55], s7 offen offset:0 sc1 lds
  v_fma_f32 v238, v238, v252, v253
  v_fma_f32 v239, v239, v252, v253
  s_waitcnt lgkmcnt(1)
  v_mfma_f32_16x16x32_bf16 v[200:203], v[88:91], v[216:219], v[200:203]
  v_mul_f32 v232, v232, v208
  v_mul_f32 v233, v233, v209
  v_mfma_f32_16x16x32_bf16 v[204:207], v[92:95], v[216:219], v[204:207]
  ds_read_b128 v[228:231], v5 offset:11264
  v_mul_f32 v234, v234, v210
  buffer_load_dwordx4 v2, s[52:55], s7 offen offset:1024 sc1 lds
  v_mul_f32 v235, v235, v211
  v_mul_f32 v236, v236, v212
  v_mfma_f32_16x16x32_bf16 v[200:203], v[96:99], v[220:223], v[200:203]
  v_mul_f32 v237, v237, v213
  v_mul_f32 v238, v238, v214
  v_mfma_f32_16x16x32_bf16 v[204:207], v[100:103], v[220:223], v[204:207]
  ds_read2st64_b64 v[216:219], v6 offset0:104 offset1:105
  v_mul_f32 v239, v239, v215
  v_exp_f32 v232, v232
  buffer_load_dwordx4 v2, s[52:55], s7 offen offset:2048 sc1 lds
  v_exp_f32 v233, v233
  s_waitcnt lgkmcnt(1)
  v_mfma_f32_16x16x32_bf16 v[200:203], v[104:107], v[224:227], v[200:203]
  v_exp_f32 v234, v234
  v_exp_f32 v235, v235
  v_mfma_f32_16x16x32_bf16 v[204:207], v[108:111], v[224:227], v[204:207]
  ds_read_b128 v[220:223], v5 offset:13312
  v_exp_f32 v236, v236
  v_exp_f32 v237, v237
  buffer_load_dwordx4 v2, s[52:55], s7 offen offset:3072 sc1 lds
  v_exp_f32 v238, v238
  v_exp_f32 v239, v239
  v_mfma_f32_16x16x32_bf16 v[200:203], v[112:115], v[228:231], v[200:203]
  v_add_f32 v232, 1.0, v232
  v_mfma_f32_16x16x32_bf16 v[204:207], v[116:119], v[228:231], v[204:207]
  ds_read_b128 v[224:227], v5 offset:14336
  v_add_f32 v233, 1.0, v233
  v_add_f32 v234, 1.0, v234
  s_add_u32 m0, s11, 44032
  s_nop 0
  buffer_load_dwordx4 v15, s[52:55], s7 offen offset:1024 sc1 lds
  v_add_f32 v235, 1.0, v235
  v_add_f32 v236, 1.0, v236
  s_waitcnt lgkmcnt(1)
  v_mfma_f32_16x16x32_bf16 v[200:203], v[120:123], v[216:219], v[200:203]
  v_add_f32 v237, 1.0, v237
  v_add_f32 v238, 1.0, v238
  v_mfma_f32_16x16x32_bf16 v[204:207], v[124:127], v[216:219], v[204:207]
  ds_read_b128 v[228:231], v5 offset:15360
  v_add_f32 v239, 1.0, v239
  v_mfma_f32_16x16x32_bf16 v[200:203], v[128:131], v[220:223], v[200:203]
  v_rcp_f32 v232, v232
  v_rcp_f32 v233, v233
  v_mfma_f32_16x16x32_bf16 v[204:207], v[132:135], v[220:223], v[204:207]
  ds_read_b128 v[216:219], v5 offset:16384
  v_rcp_f32 v234, v234
  v_rcp_f32 v235, v235
  s_waitcnt lgkmcnt(1)
  v_mfma_f32_16x16x32_bf16 v[200:203], v[136:139], v[224:227], v[200:203]
  v_rcp_f32 v236, v236
  v_rcp_f32 v237, v237
  v_mfma_f32_16x16x32_bf16 v[204:207], v[140:143], v[224:227], v[204:207]
  ds_read2st64_b64 v[220:223], v6 offset0:114 offset1:115
  v_rcp_f32 v238, v238
  v_mfma_f32_16x16x32_bf16 v[200:203], v[144:147], v[228:231], v[200:203]
  v_rcp_f32 v239, v239
  v_mul_f32 v208, v208, v232
  v_mfma_f32_16x16x32_bf16 v[204:207], v[148:151], v[228:231], v[204:207]
  ds_read_b128 v[224:227], v5 offset:18432
  v_mul_f32 v209, v209, v233
  v_mul_f32 v210, v210, v234
  s_waitcnt lgkmcnt(1)
  v_mfma_f32_16x16x32_bf16 v[200:203], v[152:155], v[216:219], v[200:203]
  v_mul_f32 v211, v211, v235
  v_mul_f32 v212, v212, v236
  v_mfma_f32_16x16x32_bf16 v[204:207], v[156:159], v[216:219], v[204:207]
  ds_read_b128 v[228:231], v5 offset:19456
  v_mul_f32 v213, v213, v237
  v_mfma_f32_16x16x32_bf16 v[200:203], v[160:163], v[220:223], v[200:203]
  v_mul_f32 v214, v214, v238
  v_mul_f32 v215, v215, v239
  v_mfma_f32_16x16x32_bf16 v[204:207], v[164:167], v[220:223], v[204:207]
  s_waitcnt vmcnt(5)
  s_barrier
  ds_read_b128 v[216:219], v4 offset:0
  v_cvt_pk_bf16_f32 v240, v208, v209
  v_cvt_pk_bf16_f32 v241, v210, v211
  s_waitcnt lgkmcnt(2)
  v_mfma_f32_16x16x32_bf16 v[200:203], v[168:171], v[224:227], v[200:203]
  v_cvt_pk_bf16_f32 v242, v212, v213
  v_cvt_pk_bf16_f32 v243, v214, v215
  v_mfma_f32_16x16x32_bf16 v[204:207], v[172:175], v[224:227], v[204:207]
  ds_read_b128 v[220:223], v4 offset:1024
  s_cmp_eq_u32 s80, 3
  s_cbranch_scc1 L_g1s
  buffer_store_dwordx4 v[240:243], v2, s[52:55], s45 offen sc1
  s_branch L_g1b
L_g1s:
  buffer_store_dwordx2 v[240:241], v7, s[52:55], s45 offen sc1
L_g1b:
  s_add_u32 s45, s45, 55296
  s_waitcnt lgkmcnt(2)
  v_mfma_f32_16x16x32_bf16 v[200:203], v[176:179], v[228:231], v[200:203]
  v_mfma_f32_16x16x32_bf16 v[204:207], v[180:183], v[228:231], v[204:207]
  ds_read2st64_b64 v[224:227], v6 offset0:4 offset1:5
  s_waitcnt lgkmcnt(2)
  v_mfma_f32_16x16x32_bf16 v[208:211], v[24:27], v[216:219], 0
  v_mfma_f32_16x16x32_bf16 v[212:215], v[28:31], v[216:219], 0
  ds_read_b128 v[228:231], v4 offset:3072
  s_waitcnt lgkmcnt(2)
  v_mfma_f32_16x16x32_bf16 v[208:211], v[32:35], v[220:223], v[208:211]
  v_mfma_f32_16x16x32_bf16 v[212:215], v[36:39], v[220:223], v[212:215]
  ds_read_b128 v[216:219], v4 offset:4096
  s_barrier
  s_waitcnt lgkmcnt(1)
  v_mfma_f32_16x16x32_bf16 v[208:211], v[40:43], v[224:227], v[208:211]
  v_fma_f32 v232, v184, v249, v192
  v_fma_f32 v233, v185, v249, v193
  s_add_u32 m0, s11, 122880
  s_add_u32 s7, s39, 655360
  buffer_load_dwordx4 v2, s[52:55], s7 offen offset:0 sc1 lds
  v_fma_f32 v234, v186, v249, v194
  v_fma_f32 v235, v187, v249, v195
  v_mfma_f32_16x16x32_bf16 v[212:215], v[44:47], v[224:227], v[212:215]
  ds_read_b128 v[220:223], v4 offset:5120
  v_fma_f32 v236, v188, v249, v196
  v_fma_f32 v237, v189, v249, v197
  v_mfma_f32_16x16x32_bf16 v[208:211], v[48:51], v[228:231], v[208:211]
  v_fma_f32 v238, v190, v249, v198
  v_fma_f32 v239, v191, v249, v199
  buffer_load_dwordx4 v2, s[52:55], s7 offen offset:1024 sc1 lds
  v_fma_f32 v200, v200, v248, v232
  v_fma_f32 v201, v201, v248, v233
  v_mfma_f32_16x16x32_bf16 v[212:215], v[52:55], v[228:231], v[212:215]
  ds_read_b128 v[224:227], v4 offset:6144
  v_fma_f32 v202, v202, v248, v234
  v_fma_f32 v203, v203, v248, v235
  s_waitcnt lgkmcnt(1)
  v_mfma_f32_16x16x32_bf16 v[208:211], v[56:59], v[216:219], v[208:211]
  v_fma_f32 v204, v204, v248, v236
  v_fma_f32 v205, v205, v248, v237
  buffer_load_dwordx4 v2, s[52:55], s7 offen offset:2048 sc1 lds
  v_fma_f32 v206, v206, v248, v238
  v_fma_f32 v207, v207, v248, v239
  v_mfma_f32_16x16x32_bf16 v[212:215], v[60:63], v[216:219], v[212:215]
  ds_read2st64_b64 v[228:231], v6 offset0:14 offset1:15
  v_mul_f32 v232, v200, v200
  v_mul_f32 v233, v201, v201
  v_mfma_f32_16x16x32_bf16 v[208:211], v[64:67], v[220:223], v[208:211]
  v_mul_f32 v234, v202, v202
  v_mul_f32 v235, v203, v203
  buffer_load_dwordx4 v2, s[52:55], s7 offen offset:3072 sc1 lds
  v_mul_f32 v236, v204, v204
  v_mul_f32 v237, v205, v205
  v_mfma_f32_16x16x32_bf16 v[212:215], v[68:71], v[220:223], v[212:215]
  ds_read_b128 v[216:219], v4 offset:8192
  v_mul_f32 v238, v206, v206
  v_mul_f32 v239, v207, v207
  s_waitcnt lgkmcnt(1)
  v_mfma_f32_16x16x32_bf16 v[208:211], v[72:75], v[224:227], v[208:211]
  v_fma_f32 v232, v232, v252, v253
  v_fma_f32 v233, v233, v252, v253
  s_add_u32 m0, s11, 125952
  s_nop 0
  buffer_load_dwordx4 v15, s[52:55], s7 offen offset:1024 sc1 lds
  v_fma_f32 v234, v234, v252, v253
  v_fma_f32 v235, v235, v252, v253
  v_mfma_f32_16x16x32_bf16 v[212:215], v[76:79], v[224:227], v[212:215]
  ds_read_b128 v[220:223], v4 offset:9216
  v_fma_f32 v236, v236, v252, v253
  v_fma_f32 v237, v237, v252, v253
  v_mfma_f32_16x16x32_bf16 v[208:211], v[80:83], v[228:231], v[208:211]
  v_fma_f32 v238, v238, v252, v253
  v_fma_f32 v239, v239, v252, v253
  v_mfma_f32_16x16x32_bf16 v[212:215], v[84:87], v[228:231], v[212:215]
  ds_read_b128 v[224:227], v4 offset:10240
  v_mul_f32 v232, v232, v200
  v_mul_f32 v233, v233, v201
  s_waitcnt lgkmcnt(1)
  v_mfma_f32_16x16x32_bf16 v[208:211], v[88:91], v[216:219], v[208:211]
  v_mul_f32 v234, v234, v202
  v_mul_f32 v235, v235, v203
  v_mfma_f32_16x16x32_bf16 v[212:215], v[92:95], v[216:219], v[212:215]
  ds_read_b128 v[228:231], v4 offset:11264
  v_mul_f32 v236, v236, v204
  v_mul_f32 v237, v237, v205
  v_mfma_f32_16x16x32_bf16 v[208:211], v[96:99], v[220:223], v[208:211]
  v_mul_f32 v238, v238, v206
  v_mul_f32 v239, v239, v207
  v_mfma_f32_16x16x32_bf16 v[212:215], v[100:103], v[220:223], v[212:215]
  ds_read2st64_b64 v[216:219], v6 offset0:24 offset1:25
  v_exp_f32 v232, v232
  v_exp_f32 v233, v233
  s_waitcnt lgkmcnt(1)
  v_mfma_f32_16x16x32_bf16 v[208:211], v[104:107], v[224:227], v[208:211]
  v_exp_f32 v234, v234
  v_exp_f32 v235, v235
  v_mfma_f32_16x16x32_bf16 v[212:215], v[108:111], v[224:227], v[212:215]
  ds_read_b128 v[220:223], v4 offset:13312
  v_exp_f32 v236, v236
  v_exp_f32 v237, v237
  v_mfma_f32_16x16x32_bf16 v[208:211], v[112:115], v[228:231], v[208:211]
  v_exp_f32 v238, v238
  v_exp_f32 v239, v239
  v_mfma_f32_16x16x32_bf16 v[212:215], v[116:119], v[228:231], v[212:215]
  ds_read_b128 v[224:227], v4 offset:14336
  v_add_f32 v232, 1.0, v232
  v_add_f32 v233, 1.0, v233
  s_waitcnt lgkmcnt(1)
  v_mfma_f32_16x16x32_bf16 v[208:211], v[120:123], v[216:219], v[208:211]
  v_add_f32 v234, 1.0, v234
  v_add_f32 v235, 1.0, v235
  v_mfma_f32_16x16x32_bf16 v[212:215], v[124:127], v[216:219], v[212:215]
  ds_read_b128 v[228:231], v4 offset:15360
  v_add_f32 v236, 1.0, v236
  v_add_f32 v237, 1.0, v237
  v_mfma_f32_16x16x32_bf16 v[208:211], v[128:131], v[220:223], v[208:211]
  v_add_f32 v238, 1.0, v238
  v_add_f32 v239, 1.0, v239
  v_mfma_f32_16x16x32_bf16 v[212:215], v[132:135], v[220:223], v[212:215]
  ds_read_b128 v[216:219], v4 offset:16384
  v_rcp_f32 v232, v232
  v_rcp_f32 v233, v233
  s_waitcnt lgkmcnt(1)
  v_mfma_f32_16x16x32_bf16 v[208:211], v[136:139], v[224:227], v[208:211]
  v_rcp_f32 v234, v234
  v_rcp_f32 v235, v235
  v_mfma_f32_16x16x32_bf16 v[212:215], v[140:143], v[224:227], v[212:215]
  ds_read2st64_b64 v[220:223], v6 offset0:34 offset1:35
  v_rcp_f32 v236, v236
  v_rcp_f32 v237, v237
  v_mfma_f32_16x16x32_bf16 v[208:211], v[144:147], v[228:231], v[208:211]
  v_rcp_f32 v238, v238
  v_rcp_f32 v239, v239
  v_mfma_f32_16x16x32_bf16 v[212:215], v[148:151], v[228:231], v[212:215]
  ds_read_b128 v[224:227], v4 offset:18432
  v_mul_f32 v200, v200, v232
  v_mul_f32 v201, v201, v233
  s_waitcnt lgkmcnt(2)
  v_mfma_f32_16x16x32_bf16 v[208:211], v[152:155], v[216:219], v[208:211]
  v_mul_f32 v202, v202, v234
  v_mul_f32 v203, v203, v235
  v_mfma_f32_16x16x32_bf16 v[212:215], v[156:159], v[216:219], v[212:215]
  ds_read_b128 v[228:231], v4 offset:19456
  v_mul_f32 v204, v204, v236
  v_mul_f32 v205, v205, v237
  s_waitcnt lgkmcnt(2)
  v_mfma_f32_16x16x32_bf16 v[208:211], v[160:163], v[220:223], v[208:211]
  v_mul_f32 v206, v206, v238
  v_mul_f32 v207, v207, v239
  v_mfma_f32_16x16x32_bf16 v[212:215], v[164:167], v[220:223], v[212:215]
  v_cvt_pk_bf16_f32 v240, v200, v201
  v_cvt_pk_bf16_f32 v241, v202, v203
  s_waitcnt lgkmcnt(1)
  v_mfma_f32_16x16x32_bf16 v[208:211], v[168:171], v[224:227], v[208:211]
  v_cvt_pk_bf16_f32 v242, v204, v205
  v_cvt_pk_bf16_f32 v243, v206, v207
  v_mfma_f32_16x16x32_bf16 v[212:215], v[172:175], v[224:227], v[212:215]
  s_cmp_eq_u32 s80, 3
  s_cbranch_scc1 L_g2s
  buffer_store_dwordx4 v[240:243], v2, s[52:55], s45 offen sc1
  s_branch L_g2b
L_g2s:
  buffer_store_dwordx2 v[240:241], v7, s[52:55], s45 offen sc1
L_g2b:
  s_add_u32 s45, s45, 55296
  s_waitcnt lgkmcnt(0)
  v_mfma_f32_16x16x32_bf16 v[208:211], v[176:179], v[228:231], v[208:211]
  v_mfma_f32_16x16x32_bf16 v[212:215], v[180:183], v[228:231], v[212:215]
  v_pk_fma_f32 v[232:233], v[250:251], v[184:185], v[192:193] op_sel:[1,0,0] op_sel_hi:[1,1,1]
  v_pk_fma_f32 v[234:235], v[250:251], v[186:187], v[194:195] op_sel:[1,0,0] op_sel_hi:[1,1,1]
  v_pk_fma_f32 v[236:237], v[250:251], v[188:189], v[196:197] op_sel:[1,0,0] op_sel_hi:[1,1,1]
  v_pk_fma_f32 v[238:239], v[250:251], v[190:191], v[198:199] op_sel:[1,0,0] op_sel_hi:[1,1,1]
  s_nop 2
  v_pk_fma_f32 v[208:209], v[208:209], v[250:251], v[232:233] op_sel_hi:[1,0,1]
  v_pk_fma_f32 v[210:211], v[210:211], v[250:251], v[234:235] op_sel_hi:[1,0,1]
  v_pk_fma_f32 v[212:213], v[212:213], v[250:251], v[236:237] op_sel_hi:[1,0,1]
  v_pk_fma_f32 v[214:215], v[214:215], v[250:251], v[238:239] op_sel_hi:[1,0,1]
  v_pk_mul_f32 v[232:233], v[208:209], v[208:209]
  v_pk_mul_f32 v[234:235], v[210:211], v[210:211]
  v_pk_mul_f32 v[236:237], v[212:213], v[212:213]
  v_pk_mul_f32 v[238:239], v[214:215], v[214:215]
  v_pk_fma_f32 v[232:233], v[232:233], v[252:253], v[252:253] op_sel:[0,0,1] op_sel_hi:[1,0,1]
  v_pk_fma_f32 v[234:235], v[234:235], v[252:253], v[252:253] op_sel:[0,0,1] op_sel_hi:[1,0,1]
  v_pk_fma_f32 v[236:237], v[236:237], v[252:253], v[252:253] op_sel:[0,0,1] op_sel_hi:[1,0,1]
  v_pk_fma_f32 v[238:239], v[238:239], v[252:253], v[252:253] op_sel:[0,0,1] op_sel_hi:[1,0,1]
  v_pk_mul_f32 v[232:233], v[232:233], v[208:209]
  v_pk_mul_f32 v[234:235], v[234:235], v[210:211]
  v_pk_mul_f32 v[236:237], v[236:237], v[212:213]
  v_pk_mul_f32 v[238:239], v[238:239], v[214:215]
  v_exp_f32 v232, v232
  v_exp_f32 v233, v233
  v_exp_f32 v234, v234
  v_exp_f32 v235, v235
  v_exp_f32 v236, v236
  v_exp_f32 v237, v237
  v_exp_f32 v238, v238
  v_exp_f32 v239, v239
  v_pk_add_f32 v[232:233], v[232:233], 1.0 op_sel_hi:[1,0]
  v_pk_add_f32 v[234:235], v[234:235], 1.0 op_sel_hi:[1,0]
  v_pk_add_f32 v[236:237], v[236:237], 1.0 op_sel_hi:[1,0]
  v_pk_add_f32 v[238:239], v[238:239], 1.0 op_sel_hi:[1,0]
  v_rcp_f32 v232, v232
  v_rcp_f32 v233, v233
  v_rcp_f32 v234, v234
  v_rcp_f32 v235, v235
  v_rcp_f32 v236, v236
  v_rcp_f32 v237, v237
  v_rcp_f32 v238, v238
  v_rcp_f32 v239, v239
  v_pk_mul_f32 v[208:209], v[208:209], v[232:233]
  v_pk_mul_f32 v[210:211], v[210:211], v[234:235]
  v_pk_mul_f32 v[212:213], v[212:213], v[236:237]
  v_pk_mul_f32 v[214:215], v[214:215], v[238:239]
  v_cvt_pk_bf16_f32 v240, v208, v209
  v_cvt_pk_bf16_f32 v241, v210, v211
  v_cvt_pk_bf16_f32 v242, v212, v213
  v_cvt_pk_bf16_f32 v243, v214, v215
  s_cmp_eq_u32 s80, 3
  s_cbranch_scc1 L_g3s
  buffer_store_dwordx4 v[240:243], v2, s[52:55], s45 offen sc1
  s_branch L_g3b
L_g3s:
  buffer_store_dwordx2 v[240:241], v7, s[52:55], s45 offen sc1
L_g3b:
  s_add_u32 s45, s45, 55296
  v_lshrrev_b32 v16, 4, v1
  v_lshlrev_b32 v16, 3, v16
  buffer_load_dwordx2 v[24:25], v16, s[68:71], s84 offen
  buffer_load_dwordx2 v[26:27], v16, s[68:71], s84 offen offset:32
  buffer_load_dwordx2 v[28:29], v16, s[68:71], s86 offen
  s_mul_i32 s78, s81, 5120
  s_lshl_b32 s79, s84, 5
  s_add_u32 s79, s79, s78
  v_add_u32 v30, s79, v2
  v_add_u32 v36, 81920, v30
  v_add_u32 v33, 40960, v30
  v_add_u32 v39, 122880, v30
  s_lshl_b32 s79, s85, 5
  s_add_u32 s79, s79, s78
  v_add_u32 v31, s79, v2
  v_add_u32 v37, 81920, v31
  v_add_u32 v34, 40960, v31
  v_add_u32 v40, 122880, v31
  s_lshl_b32 s79, s86, 5
  s_add_u32 s79, s79, s78
  v_add_u32 v32, s79, v2
  v_add_u32 v38, 81920, v32
  v_add_u32 v35, 40960, v32
  v_add_u32 v41, 122880, v32
  ds_read_b128 v[112:115], v30 offset:0
  ds_read_b128 v[116:119], v30 offset:1024
  ds_read_b128 v[120:123], v31 offset:0
  ds_read_b128 v[124:127], v31 offset:1024
  ds_read_b128 v[128:131], v32 offset:0
  ds_read_b128 v[132:135], v30 offset:10240
  ds_read_b128 v[136:139], v30 offset:11264
  ds_read_b128 v[140:143], v31 offset:10240
  ds_read_b128 v[144:147], v31 offset:11264
  ds_read_b128 v[148:151], v32 offset:10240
  ds_read_b128 v[152:155], v30 offset:20480
  ds_read_b128 v[156:159], v30 offset:21504
  ds_read_b128 v[160:163], v31 offset:20480
  ds_read_b128 v[164:167], v31 offset:21504
  ds_read_b128 v[168:171], v32 offset:20480
  ds_read_b128 v[172:175], v30 offset:30720
  ds_read_b128 v[176:179], v30 offset:31744
  ds_read_b128 v[180:183], v31 offset:30720
  ds_read_b128 v[184:187], v31 offset:31744
  ds_read_b128 v[188:191], v32 offset:30720
  s_mul_i32 s72, s83, 54
  s_add_u32 s72, s72, s81
  s_lshl_b32 s72, s72, 10
  s_add_u32 s72, s72, 9437184
  s_mul_i32 s78, s26, 3072
  s_add_u32 s78, s78, 81920
  v_add_u32 v42, s78, v2
  s_xor_b32 s78, s26, 4
  s_mul_i32 s78, s78, 3072
  s_add_u32 s78, s78, 81920
  v_add_u32 v43, s78, v2
  s_add_u32 s73, s87, s84
  s_add_u32 s74, s87, s86
  s_cmp_lg_u32 s81, 0
  s_cselect_b32 s74, 0x4000000, s74
  s_cselect_b32 s75, 0, 1.0
  s_cselect_b64 vcc, -1, 0
  s_lshl_b32 s1, s27, 7
  s_add_u32 s1, s1, 79872
  s_lshl_b32 s77, s29, 7
  s_add_u32 s77, s77, 79872
  s_waitcnt lgkmcnt(0)
  s_waitcnt vmcnt(3)
  s_barrier
  s_cmp_lg_u32 s26, 7
  s_cbranch_scc1 L_s3sig_e
  s_atomic_add s3, s[24:25], s1
L_s3sig_e:
  ds_read_b128 v[192:195], v33 offset:0
  ds_read_b128 v[196:199], v33 offset:1024
  ds_read_b128 v[200:203], v34 offset:0
  ds_read_b128 v[204:207], v34 offset:1024
  ds_read_b128 v[208:211], v35 offset:0
  s_add_u32 m0, s11, 81920
  s_add_u32 s7, s39, 983040
  buffer_load_dwordx4 v2, s[52:55], s7 offen offset:0 sc1 lds
  buffer_load_dwordx4 v2, s[52:55], s7 offen offset:1024 sc1 lds
  buffer_load_dwordx4 v2, s[52:55], s7 offen offset:2048 sc1 lds
  buffer_load_dwordx4 v2, s[52:55], s7 offen offset:3072 sc1 lds
  s_add_u32 m0, s11, 84992
  s_nop 0
  buffer_load_dwordx4 v15, s[52:55], s7 offen offset:1024 sc1 lds
  s_add_u32 m0, s11, 0
  s_add_u32 s7, s39, 1310720
  buffer_load_dwordx4 v2, s[52:55], s7 offen offset:0 sc1 lds
  buffer_load_dwordx4 v2, s[52:55], s7 offen offset:1024 sc1 lds
  buffer_load_dwordx4 v2, s[52:55], s7 offen offset:2048 sc1 lds
  buffer_load_dwordx4 v2, s[52:55], s7 offen offset:3072 sc1 lds
  s_add_u32 m0, s11, 3072
  s_nop 0
  buffer_load_dwordx4 v15, s[52:55], s7 offen offset:1024 sc1 lds
  v_lshlrev_b32 v44, 16, v8
  v_and_b32 v45, 0xffff0000, v8
  s_waitcnt vmcnt(12)
  v_lshlrev_b32 v64, 16, v24
  v_and_b32 v65, 0xffff0000, v24
  v_pk_add_f32 v[44:45], v[44:45], v[64:65]
  v_lshlrev_b32 v46, 16, v9
  v_and_b32 v47, 0xffff0000, v9
  v_lshlrev_b32 v64, 16, v25
  v_and_b32 v65, 0xffff0000, v25
  v_pk_add_f32 v[46:47], v[46:47], v[64:65]
  v_lshlrev_b32 v48, 16, v10
  v_and_b32 v49, 0xffff0000, v10
  s_waitcnt vmcnt(11)
  v_lshlrev_b32 v64, 16, v26
  v_and_b32 v65, 0xffff0000, v26
  v_pk_add_f32 v[48:49], v[48:49], v[64:65]
  v_lshlrev_b32 v50, 16, v11
  v_and_b32 v51, 0xffff0000, v11
  v_lshlrev_b32 v64, 16, v27
  v_and_b32 v65, 0xffff0000, v27
  v_pk_add_f32 v[50:51], v[50:51], v[64:65]
  v_lshlrev_b32 v60, 16, v12
  v_and_b32 v61, 0xffff0000, v12
  s_waitcnt vmcnt(10)
  v_lshlrev_b32 v64, 16, v28
  v_and_b32 v65, 0xffff0000, v28
  v_pk_add_f32 v[60:61], v[60:61], v[64:65]
  v_lshlrev_b32 v62, 16, v13
  v_and_b32 v63, 0xffff0000, v13
  v_lshlrev_b32 v64, 16, v29
  v_and_b32 v65, 0xffff0000, v29
  v_pk_add_f32 v[62:63], v[62:63], v[64:65]
  v_mul_f32 v60, s75, v60
  v_mul_f32 v61, s75, v61
  v_mul_f32 v62, s75, v62
  v_mul_f32 v63, s75, v63
  v_and_b32 v17, 15, v1
  v_mul_u32_u24 v17, 1280, v17
  v_bfe_u32 v18, v1, 4, 1
  v_lshl_add_u32 v17, v18, 5, v17
  v_lshrrev_b32 v18, 5, v1
  v_lshl_add_u32 v17, v18, 4, v17
  s_cmp_lg_u32 s26, 7
  s_cbranch_scc1 L_s3pol_e
  s_waitcnt lgkmcnt(0)
  s_mov_b32 s79, 0x400000
L_s3_p:
  s_mov_b32 s0, 0
  s_atomic_add s0, s[24:25], s77 glc
  s_sub_u32 s79, s79, 1
  s_cselect_b32 s1, 0, 16
  s_waitcnt lgkmcnt(0)
  s_cmp_ge_u32 s0, s1
  s_cbranch_scc1 L_s3_d
  s_sleep 2
  s_branch L_s3_p
L_s3_d:
L_s3pol_e:
  s_barrier
  buffer_load_dwordx4 v[64:67], v2, s[52:55], s72 offen offset:0 sc1
  s_cbranch_vccz L_xn1
  buffer_load_dwordx2 v[68:69], v7, s[52:55], s72 offen offset:2048 sc1
  buffer_load_dwordx2 v[70:71], v7, s[52:55], s72 offen offset:2560 sc1
  s_branch L_xj1
L_xn1:
  buffer_load_dwordx4 v[68:71], v2, s[52:55], s72 offen offset:2048 sc1
L_xj1:
  s_add_u32 s72, s72, 4096
  buffer_load_dwordx4 v[72:75], v2, s[52:55], s72 offen offset:0 sc1
  buffer_load_dwordx4 v[76:79], v2, s[52:55], s72 offen offset:2048 sc1
  s_add_u32 s72, s72, 4096
  buffer_load_dwordx4 v[80:83], v2, s[52:55], s72 offen offset:0 sc1
  s_cbranch_vccnz L_xn5
  buffer_load_dwordx2 v[84:85], v7, s[52:55], s72 offen offset:2048 sc1
  buffer_load_dwordx2 v[86:87], v7, s[52:55], s72 offen offset:2560 sc1
  s_branch L_xj5
L_xn5:
  buffer_load_dwordx4 v[84:87], v2, s[52:55], s72 offen offset:2048 sc1
L_xj5:
  s_add_u32 s72, s72, 4096
  s_waitcnt vmcnt(5)
  v_mfma_f32_16x16x32_bf16 v[44:47], v[112:115], v[64:67], v[44:47]
  v_mfma_f32_16x16x32_bf16 v[48:51], v[116:119], v[64:67], v[48:51]
  v_mfma_f32_16x16x32_bf16 v[52:55], v[120:123], v[64:67], 0
  v_mfma_f32_16x16x32_bf16 v[56:59], v[124:127], v[64:67], 0
  v_mfma_f32_16x16x32_bf16 v[60:63], v[128:131], v[64:67], v[60:63]
  buffer_load_dwordx4 v[88:91], v2, s[52:55], s72 offen offset:0 sc1
  buffer_load_dwordx4 v[92:95], v2, s[52:55], s72 offen offset:2048 sc1
  s_add_u32 s72, s72, 4096
  s_waitcnt vmcnt(6)
  v_mfma_f32_16x16x32_bf16 v[44:47], v[132:135], v[68:71], v[44:47]
  v_mfma_f32_16x16x32_bf16 v[48:51], v[136:139], v[68:71], v[48:51]
  v_mfma_f32_16x16x32_bf16 v[52:55], v[140:143], v[68:71], v[52:55]
  v_mfma_f32_16x16x32_bf16 v[56:59], v[144:147], v[68:71], v[56:59]
  v_mfma_f32_16x16x32_bf16 v[60:63], v[148:151], v[68:71], v[60:63]
  s_cbranch_vccz L_xn8
  buffer_load_dwordx2 v[96:97], v7, s[52:55], s72 offen offset:0 sc1
  buffer_load_dwordx2 v[98:99], v7, s[52:55], s72 offen offset:512 sc1
  s_branch L_xj8
L_xn8:
  buffer_load_dwordx4 v[96:99], v2, s[52:55], s72 offen offset:0 sc1
L_xj8:
  buffer_load_dwordx4 v[100:103], v2, s[52:55], s72 offen offset:2048 sc1
  s_add_u32 s72, s72, 4096
  s_waitcnt vmcnt(7)
  v_mfma_f32_16x16x32_bf16 v[44:47], v[152:155], v[72:75], v[44:47]
  v_mfma_f32_16x16x32_bf16 v[48:51], v[156:159], v[72:75], v[48:51]
  v_mfma_f32_16x16x32_bf16 v[52:55], v[160:163], v[72:75], v[52:55]
  v_mfma_f32_16x16x32_bf16 v[56:59], v[164:167], v[72:75], v[56:59]
  v_mfma_f32_16x16x32_bf16 v[60:63], v[168:171], v[72:75], v[60:63]
  buffer_load_dwordx4 v[104:107], v2, s[52:55], s72 offen offset:0 sc1
  buffer_load_dwordx4 v[108:111], v2, s[52:55], s72 offen offset:2048 sc1
  s_add_u32 s72, s72, 4096
  s_waitcnt vmcnt(8)
  v_mfma_f32_16x16x32_bf16 v[44:47], v[172:175], v[76:79], v[44:47]
  v_mfma_f32_16x16x32_bf16 v[48:51], v[176:179], v[76:79], v[48:51]
  v_mfma_f32_16x16x32_bf16 v[52:55], v[180:183], v[76:79], v[52:55]
  v_mfma_f32_16x16x32_bf16 v[56:59], v[184:187], v[76:79], v[56:59]
  v_mfma_f32_16x16x32_bf16 v[60:63], v[188:191], v[76:79], v[60:63]
  s_cbranch_vccnz L_xn12
  buffer_load_dwordx2 v[64:65], v7, s[52:55], s72 offen offset:0 sc1
  buffer_load_dwordx2 v[66:67], v7, s[52:55], s72 offen offset:512 sc1
  s_branch L_xj12
L_xn12:
  buffer_load_dwordx4 v[64:67], v2, s[52:55], s72 offen offset:0 sc1
L_xj12:
  buffer_load_dwordx4 v[68:71], v2, s[52:55], s72 offen offset:2048 sc1
  s_add_u32 s72, s72, 4096
  s_waitcnt vmcnt(9) lgkmcnt(4)
  v_mfma_f32_16x16x32_bf16 v[44:47], v[192:195], v[80:83], v[44:47]
  ds_read_b128 v[212:215], v33 offset:10240
  s_waitcnt lgkmcnt(4)
  v_mfma_f32_16x16x32_bf16 v[48:51], v[196:199], v[80:83], v[48:51]
  ds_read_b128 v[216:219], v33 offset:11264
  s_waitcnt lgkmcnt(4)
  v_mfma_f32_16x16x32_bf16 v[52:55], v[200:203], v[80:83], v[52:55]
  ds_read_b128 v[220:223], v34 offset:10240
  s_waitcnt lgkmcnt(4)
  v_mfma_f32_16x16x32_bf16 v[56:59], v[204:207], v[80:83], v[56:59]
  ds_read_b128 v[224:227], v34 offset:11264
  s_waitcnt lgkmcnt(4)
  v_mfma_f32_16x16x32_bf16 v[60:63], v[208:211], v[80:83], v[60:63]
  ds_read_b128 v[228:231], v35 offset:10240
  buffer_load_dwordx4 v[72:75], v2, s[52:55], s72 offen offset:0 sc1
  s_cbranch_vccz L_xn15
  buffer_load_dwordx2 v[76:77], v7, s[52:55], s72 offen offset:2048 sc1
  buffer_load_dwordx2 v[78:79], v7, s[52:55], s72 offen offset:2560 sc1
  s_branch L_xj15
L_xn15:
  buffer_load_dwordx4 v[76:79], v2, s[52:55], s72 offen offset:2048 sc1
L_xj15:
  s_add_u32 s72, s72, 4096
  s_waitcnt vmcnt(10) lgkmcnt(4)
  v_mfma_f32_16x16x32_bf16 v[44:47], v[212:215], v[84:87], v[44:47]
  ds_read_b128 v[192:195], v33 offset:20480
  s_waitcnt lgkmcnt(4)
  v_mfma_f32_16x16x32_bf16 v[48:51], v[216:219], v[84:87], v[48:51]
  ds_read_b128 v[196:199], v33 offset:21504
  s_waitcnt lgkmcnt(4)
  v_mfma_f32_16x16x32_bf16 v[52:55], v[220:223], v[84:87], v[52:55]
  ds_read_b128 v[200:203], v34 offset:20480
  s_waitcnt lgkmcnt(4)
  v_mfma_f32_16x16x32_bf16 v[56:59], v[224:227], v[84:87], v[56:59]
  ds_read_b128 v[204:207], v34 offset:21504
  s_waitcnt lgkmcnt(4)
  v_mfma_f32_16x16x32_bf16 v[60:63], v[228:231], v[84:87], v[60:63]
  ds_read_b128 v[208:211], v35 offset:20480
  buffer_load_dwordx4 v[80:83], v2, s[52:55], s72 offen offset:0 sc1
  buffer_load_dwordx4 v[84:87], v2, s[52:55], s72 offen offset:2048 sc1
  s_add_u32 s72, s72, 4096
  s_waitcnt vmcnt(11) lgkmcnt(4)
  v_mfma_f32_16x16x32_bf16 v[44:47], v[192:195], v[88:91], v[44:47]
  ds_read_b128 v[212:215], v33 offset:30720
  s_waitcnt lgkmcnt(4)
  v_mfma_f32_16x16x32_bf16 v[48:51], v[196:199], v[88:91], v[48:51]
  ds_read_b128 v[216:219], v33 offset:31744
  s_waitcnt lgkmcnt(4)
  v_mfma_f32_16x16x32_bf16 v[52:55], v[200:203], v[88:91], v[52:55]
  ds_read_b128 v[220:223], v34 offset:30720
  s_waitcnt lgkmcnt(4)
  v_mfma_f32_16x16x32_bf16 v[56:59], v[204:207], v[88:91], v[56:59]
  ds_read_b128 v[224:227], v34 offset:31744
  s_waitcnt lgkmcnt(4)
  v_mfma_f32_16x16x32_bf16 v[60:63], v[208:211], v[88:91], v[60:63]
  ds_read_b128 v[228:231], v35 offset:30720
  buffer_load_dwordx4 v[88:91], v2, s[52:55], s72 offen offset:0 sc1
  s_waitcnt vmcnt(11) lgkmcnt(4)
  v_mfma_f32_16x16x32_bf16 v[44:47], v[212:215], v[92:95], v[44:47]
  ds_read_b128 v[192:195], v39 offset:0
  s_waitcnt lgkmcnt(4)
  v_mfma_f32_16x16x32_bf16 v[48:51], v[216:219], v[92:95], v[48:51]
  ds_read_b128 v[196:199], v39 offset:1024
  s_waitcnt lgkmcnt(4)
  v_mfma_f32_16x16x32_bf16 v[52:55], v[220:223], v[92:95], v[52:55]
  ds_read_b128 v[200:203], v40 offset:0
  s_waitcnt lgkmcnt(4)
  v_mfma_f32_16x16x32_bf16 v[56:59], v[224:227], v[92:95], v[56:59]
  ds_read_b128 v[204:207], v40 offset:1024
  s_waitcnt lgkmcnt(4)
  v_mfma_f32_16x16x32_bf16 v[60:63], v[228:231], v[92:95], v[60:63]
  ds_read_b128 v[208:211], v41 offset:0
  s_cbranch_vccnz L_xn19
  buffer_load_dwordx2 v[92:93], v7, s[52:55], s72 offen offset:2048 sc1
  buffer_load_dwordx2 v[94:95], v7, s[52:55], s72 offen offset:2560 sc1
  s_branch L_xj19
L_xn19:
  buffer_load_dwordx4 v[92:95], v2, s[52:55], s72 offen offset:2048 sc1
L_xj19:
  s_add_u32 s72, s72, 4096
  s_waitcnt vmcnt(11) lgkmcnt(4)
  v_mfma_f32_16x16x32_bf16 v[44:47], v[192:195], v[96:99], v[44:47]
  ds_read_b128 v[212:215], v39 offset:10240
  s_waitcnt lgkmcnt(4)
  v_mfma_f32_16x16x32_bf16 v[48:51], v[196:199], v[96:99], v[48:51]
  ds_read_b128 v[216:219], v39 offset:11264
  s_waitcnt lgkmcnt(4)
  v_mfma_f32_16x16x32_bf16 v[52:55], v[200:203], v[96:99], v[52:55]
  ds_read_b128 v[220:223], v40 offset:10240
  s_waitcnt lgkmcnt(4)
  v_mfma_f32_16x16x32_bf16 v[56:59], v[204:207], v[96:99], v[56:59]
  ds_read_b128 v[224:227], v40 offset:11264
  s_waitcnt lgkmcnt(4)
  v_mfma_f32_16x16x32_bf16 v[60:63], v[208:211], v[96:99], v[60:63]
  ds_read_b128 v[228:231], v41 offset:10240
  buffer_load_dwordx4 v[96:99], v2, s[52:55], s72 offen offset:0 sc1
  s_waitcnt vmcnt(11) lgkmcnt(4)
  v_mfma_f32_16x16x32_bf16 v[44:47], v[212:215], v[100:103], v[44:47]
  ds_read_b128 v[192:195], v39 offset:20480
  s_waitcnt lgkmcnt(4)
  v_mfma_f32_16x16x32_bf16 v[48:51], v[216:219], v[100:103], v[48:51]
  ds_read_b128 v[196:199], v39 offset:21504
  s_waitcnt lgkmcnt(4)
  v_mfma_f32_16x16x32_bf16 v[52:55], v[220:223], v[100:103], v[52:55]
  ds_read_b128 v[200:203], v40 offset:20480
  s_waitcnt lgkmcnt(4)
  v_mfma_f32_16x16x32_bf16 v[56:59], v[224:227], v[100:103], v[56:59]
  ds_read_b128 v[204:207], v40 offset:21504
  s_waitcnt lgkmcnt(4)
  v_mfma_f32_16x16x32_bf16 v[60:63], v[228:231], v[100:103], v[60:63]
  ds_read_b128 v[208:211], v41 offset:20480
  buffer_load_dwordx4 v[100:103], v2, s[52:55], s72 offen offset:2048 sc1
  s_add_u32 s72, s72, 4096
  s_waitcnt vmcnt(11) lgkmcnt(4)
  v_mfma_f32_16x16x32_bf16 v[44:47], v[192:195], v[104:107], v[44:47]
  ds_read_b128 v[212:215], v39 offset:30720
  s_waitcnt lgkmcnt(4)
  v_mfma_f32_16x16x32_bf16 v[48:51], v[196:199], v[104:107], v[48:51]
  ds_read_b128 v[216:219], v39 offset:31744
  s_waitcnt lgkmcnt(4)
  v_mfma_f32_16x16x32_bf16 v[52:55], v[200:203], v[104:107], v[52:55]
  ds_read_b128 v[220:223], v40 offset:30720
  s_waitcnt lgkmcnt(4)
  v_mfma_f32_16x16x32_bf16 v[56:59], v[204:207], v[104:107], v[56:59]
  ds_read_b128 v[224:227], v40 offset:31744
  s_waitcnt lgkmcnt(4)
  v_mfma_f32_16x16x32_bf16 v[60:63], v[208:211], v[104:107], v[60:63]
  ds_read_b128 v[228:231], v41 offset:30720
  buffer_load_dwordx4 v[104:107], v2, s[52:55], s72 offen offset:0 sc1
  s_barrier
  s_waitcnt vmcnt(11) lgkmcnt(4)
  v_mfma_f32_16x16x32_bf16 v[44:47], v[212:215], v[108:111], v[44:47]
  ds_read_b128 v[192:195], v36 offset:0
  ds_read_b128 v[196:199], v36 offset:1024
  s_waitcnt lgkmcnt(5)
  v_mfma_f32_16x16x32_bf16 v[48:51], v[216:219], v[108:111], v[48:51]
  ds_read_b128 v[200:203], v37 offset:0
  ds_read_b128 v[204:207], v37 offset:1024
  s_waitcnt lgkmcnt(6)
  v_mfma_f32_16x16x32_bf16 v[52:55], v[220:223], v[108:111], v[52:55]
  ds_read_b128 v[208:211], v38 offset:0
  s_add_u32 m0, s11, 40960
  s_add_u32 s7, s39, 1638400
  buffer_load_dwordx4 v2, s[52:55], s7 offen offset:0 sc1 lds
  s_waitcnt lgkmcnt(6)
  v_mfma_f32_16x16x32_bf16 v[56:59], v[224:227], v[108:111], v[56:59]
  buffer_load_dwordx4 v2, s[52:55], s7 offen offset:1024 sc1 lds
  buffer_load_dwordx4 v2, s[52:55], s7 offen offset:2048 sc1 lds
  s_waitcnt lgkmcnt(5)
  v_mfma_f32_16x16x32_bf16 v[60:63], v[228:231], v[108:111], v[60:63]
  buffer_load_dwordx4 v2, s[52:55], s7 offen offset:3072 sc1 lds
  s_add_u32 m0, s11, 44032
  s_nop 0
  buffer_load_dwordx4 v15, s[52:55], s7 offen offset:1024 sc1 lds
  buffer_load_dwordx4 v[108:111], v2, s[52:55], s72 offen offset:2048 sc1
  s_add_u32 s72, s72, 4096
  s_waitcnt vmcnt(16) lgkmcnt(4)
  v_mfma_f32_16x16x32_bf16 v[44:47], v[192:195], v[64:67], v[44:47]
  ds_read_b128 v[212:215], v36 offset:10240
  s_waitcnt lgkmcnt(4)
  v_mfma_f32_16x16x32_bf16 v[48:51], v[196:199], v[64:67], v[48:51]
  ds_read_b128 v[216:219], v36 offset:11264
  s_waitcnt lgkmcnt(4)
  v_mfma_f32_16x16x32_bf16 v[52:55], v[200:203], v[64:67], v[52:55]
  ds_read_b128 v[220:223], v37 offset:10240
  s_waitcnt lgkmcnt(4)
  v_mfma_f32_16x16x32_bf16 v[56:59], v[204:207], v[64:67], v[56:59]
  ds_read_b128 v[224:227], v37 offset:11264
  s_waitcnt lgkmcnt(4)
  v_mfma_f32_16x16x32_bf16 v[60:63], v[208:211], v[64:67], v[60:63]
  ds_read_b128 v[228:231], v38 offset:10240
  buffer_load_dwordx4 v[64:67], v2, s[52:55], s72 offen offset:0 sc1
  s_waitcnt vmcnt(16) lgkmcnt(4)
  v_mfma_f32_16x16x32_bf16 v[44:47], v[212:215], v[68:71], v[44:47]
  ds_read_b128 v[192:195], v36 offset:20480
  s_waitcnt lgkmcnt(4)
  v_mfma_f32_16x16x32_bf16 v[48:51], v[216:219], v[68:71], v[48:51]
  ds_read_b128 v[196:199], v36 offset:21504
  s_waitcnt lgkmcnt(4)
  v_mfma_f32_16x16x32_bf16 v[52:55], v[220:223], v[68:71], v[52:55]
  ds_read_b128 v[200:203], v37 offset:20480
  s_waitcnt lgkmcnt(4)
  v_mfma_f32_16x16x32_bf16 v[56:59], v[224:227], v[68:71], v[56:59]
  ds_read_b128 v[204:207], v37 offset:21504
  s_waitcnt lgkmcnt(4)
  v_mfma_f32_16x16x32_bf16 v[60:63], v[228:231], v[68:71], v[60:63]
  ds_read_b128 v[208:211], v38 offset:20480
  buffer_load_dwordx4 v[68:71], v2, s[52:55], s72 offen offset:2048 sc1
  s_add_u32 s72, s72, 4096
  s_waitcnt vmcnt(16) lgkmcnt(4)
  v_mfma_f32_16x16x32_bf16 v[44:47], v[192:195], v[72:75], v[44:47]
  ds_read_b128 v[212:215], v36 offset:30720
  s_waitcnt lgkmcnt(4)
  v_mfma_f32_16x16x32_bf16 v[48:51], v[196:199], v[72:75], v[48:51]
  ds_read_b128 v[216:219], v36 offset:31744
  s_waitcnt lgkmcnt(4)
  v_mfma_f32_16x16x32_bf16 v[52:55], v[200:203], v[72:75], v[52:55]
  ds_read_b128 v[220:223], v37 offset:30720
  s_waitcnt lgkmcnt(4)
  v_mfma_f32_16x16x32_bf16 v[56:59], v[204:207], v[72:75], v[56:59]
  ds_read_b128 v[224:227], v37 offset:31744
  s_waitcnt lgkmcnt(4)
  v_mfma_f32_16x16x32_bf16 v[60:63], v[208:211], v[72:75], v[60:63]
  ds_read_b128 v[228:231], v38 offset:30720
  buffer_load_dwordx4 v[72:75], v2, s[52:55], s72 offen offset:0 sc1
  s_barrier
  s_waitcnt vmcnt(16) lgkmcnt(4)
  v_mfma_f32_16x16x32_bf16 v[44:47], v[212:215], v[76:79], v[44:47]
  ds_read_b128 v[192:195], v30 offset:0
  ds_read_b128 v[196:199], v30 offset:1024
  s_waitcnt lgkmcnt(5)
  v_mfma_f32_16x16x32_bf16 v[48:51], v[216:219], v[76:79], v[48:51]
  ds_read_b128 v[200:203], v31 offset:0
  ds_read_b128 v[204:207], v31 offset:1024
  s_waitcnt lgkmcnt(6)
  v_mfma_f32_16x16x32_bf16 v[52:55], v[220:223], v[76:79], v[52:55]
  ds_read_b128 v[208:211], v32 offset:0
  s_add_u32 m0, s11, 122880
  s_add_u32 s7, s39, 1966080
  s_cmp_ge_u32 s26, 6
  s_cselect_b32 s7, 33554432, s7
  buffer_load_dwordx4 v2, s[52:55], s7 offen offset:0 sc1 lds
  s_waitcnt lgkmcnt(6)
  v_mfma_f32_16x16x32_bf16 v[56:59], v[224:227], v[76:79], v[56:59]
  buffer_load_dwordx4 v2, s[52:55], s7 offen offset:1024 sc1 lds
  buffer_load_dwordx4 v2, s[52:55], s7 offen offset:2048 sc1 lds
  s_waitcnt lgkmcnt(5)
  v_mfma_f32_16x16x32_bf16 v[60:63], v[228:231], v[76:79], v[60:63]
  buffer_load_dwordx4 v2, s[52:55], s7 offen offset:3072 sc1 lds
  s_add_u32 m0, s11, 125952
  s_nop 0
  buffer_load_dwordx4 v15, s[52:55], s7 offen offset:1024 sc1 lds
  s_waitcnt vmcnt(20) lgkmcnt(4)
  v_mfma_f32_16x16x32_bf16 v[44:47], v[192:195], v[80:83], v[44:47]
  ds_read_b128 v[212:215], v30 offset:10240
  s_waitcnt lgkmcnt(4)
  v_mfma_f32_16x16x32_bf16 v[48:51], v[196:199], v[80:83], v[48:51]
  ds_read_b128 v[216:219], v30 offset:11264
  s_waitcnt lgkmcnt(4)
  v_mfma_f32_16x16x32_bf16 v[52:55], v[200:203], v[80:83], v[52:55]
  ds_read_b128 v[220:223], v31 offset:10240
  s_waitcnt lgkmcnt(4)
  v_mfma_f32_16x16x32_bf16 v[56:59], v[204:207], v[80:83], v[56:59]
  ds_read_b128 v[224:227], v31 offset:11264
  s_waitcnt lgkmcnt(4)
  v_mfma_f32_16x16x32_bf16 v[60:63], v[208:211], v[80:83], v[60:63]
  ds_read_b128 v[228:231], v32 offset:10240
  s_waitcnt vmcnt(19) lgkmcnt(4)
  v_mfma_f32_16x16x32_bf16 v[44:47], v[212:215], v[84:87], v[44:47]
  ds_read_b128 v[192:195], v30 offset:20480
  s_waitcnt lgkmcnt(4)
  v_mfma_f32_16x16x32_bf16 v[48:51], v[216:219], v[84:87], v[48:51]
  ds_read_b128 v[196:199], v30 offset:21504
  s_waitcnt lgkmcnt(4)
  v_mfma_f32_16x16x32_bf16 v[52:55], v[220:223], v[84:87], v[52:55]
  ds_read_b128 v[200:203], v31 offset:20480
  s_waitcnt lgkmcnt(4)
  v_mfma_f32_16x16x32_bf16 v[56:59], v[224:227], v[84:87], v[56:59]
  ds_read_b128 v[204:207], v31 offset:21504
  s_waitcnt lgkmcnt(4)
  v_mfma_f32_16x16x32_bf16 v[60:63], v[228:231], v[84:87], v[60:63]
  ds_read_b128 v[208:211], v32 offset:20480
  s_waitcnt vmcnt(18) lgkmcnt(4)
  v_mfma_f32_16x16x32_bf16 v[44:47], v[192:195], v[88:91], v[44:47]
  ds_read_b128 v[212:215], v30 offset:30720
  s_waitcnt lgkmcnt(4)
  v_mfma_f32_16x16x32_bf16 v[48:51], v[196:199], v[88:91], v[48:51]
  ds_read_b128 v[216:219], v30 offset:31744
  s_waitcnt lgkmcnt(4)
  v_mfma_f32_16x16x32_bf16 v[52:55], v[200:203], v[88:91], v[52:55]
  ds_read_b128 v[220:223], v31 offset:30720
  s_waitcnt lgkmcnt(4)
  v_mfma_f32_16x16x32_bf16 v[56:59], v[204:207], v[88:91], v[56:59]
  ds_read_b128 v[224:227], v31 offset:31744
  s_waitcnt lgkmcnt(4)
  v_mfma_f32_16x16x32_bf16 v[60:63], v[208:211], v[88:91], v[60:63]
  ds_read_b128 v[228:231], v32 offset:30720
  s_waitcnt vmcnt(9)
  s_barrier
  s_waitcnt lgkmcnt(4)
  v_mfma_f32_16x16x32_bf16 v[44:47], v[212:215], v[92:95], v[44:47]
  ds_read_b128 v[192:195], v33 offset:0
  s_waitcnt lgkmcnt(4)
  v_mfma_f32_16x16x32_bf16 v[48:51], v[216:219], v[92:95], v[48:51]
  ds_read_b128 v[196:199], v33 offset:1024
  s_waitcnt lgkmcnt(4)
  v_mfma_f32_16x16x32_bf16 v[52:55], v[220:223], v[92:95], v[52:55]
  ds_read_b128 v[200:203], v34 offset:0
  s_waitcnt lgkmcnt(4)
  v_mfma_f32_16x16x32_bf16 v[56:59], v[224:227], v[92:95], v[56:59]
  ds_read_b128 v[204:207], v34 offset:1024
  s_waitcnt lgkmcnt(4)
  v_mfma_f32_16x16x32_bf16 v[60:63], v[228:231], v[92:95], v[60:63]
  ds_read_b128 v[208:211], v35 offset:0
  s_waitcnt lgkmcnt(4)
  v_mfma_f32_16x16x32_bf16 v[44:47], v[192:195], v[96:99], v[44:47]
  ds_read_b128 v[212:215], v33 offset:10240
  s_waitcnt lgkmcnt(4)
  v_mfma_f32_16x16x32_bf16 v[48:51], v[196:199], v[96:99], v[48:51]
  ds_read_b128 v[216:219], v33 offset:11264
  s_waitcnt lgkmcnt(4)
  v_mfma_f32_16x16x32_bf16 v[52:55], v[200:203], v[96:99], v[52:55]
  ds_read_b128 v[220:223], v34 offset:10240
  s_waitcnt lgkmcnt(4)
  v_mfma_f32_16x16x32_bf16 v[56:59], v[204:207], v[96:99], v[56:59]
  ds_read_b128 v[224:227], v34 offset:11264
  s_waitcnt lgkmcnt(4)
  v_mfma_f32_16x16x32_bf16 v[60:63], v[208:211], v[96:99], v[60:63]
  ds_read_b128 v[228:231], v35 offset:10240
  s_waitcnt lgkmcnt(4)
  v_mfma_f32_16x16x32_bf16 v[44:47], v[212:215], v[100:103], v[44:47]
  ds_read_b128 v[192:195], v33 offset:20480
  s_waitcnt lgkmcnt(4)
  v_mfma_f32_16x16x32_bf16 v[48:51], v[216:219], v[100:103], v[48:51]
  ds_read_b128 v[196:199], v33 offset:21504
  s_waitcnt lgkmcnt(4)
  v_mfma_f32_16x16x32_bf16 v[52:55], v[220:223], v[100:103], v[52:55]
  ds_read_b128 v[200:203], v34 offset:20480
  s_waitcnt lgkmcnt(4)
  v_mfma_f32_16x16x32_bf16 v[56:59], v[224:227], v[100:103], v[56:59]
  ds_read_b128 v[204:207], v34 offset:21504
  s_waitcnt lgkmcnt(4)
  v_mfma_f32_16x16x32_bf16 v[60:63], v[228:231], v[100:103], v[60:63]
  ds_read_b128 v[208:211], v35 offset:20480
  s_waitcnt lgkmcnt(4)
  v_mfma_f32_16x16x32_bf16 v[44:47], v[192:195], v[104:107], v[44:47]
  ds_read_b128 v[212:215], v33 offset:30720
  s_waitcnt lgkmcnt(4)
  v_mfma_f32_16x16x32_bf16 v[48:51], v[196:199], v[104:107], v[48:51]
  ds_read_b128 v[216:219], v33 offset:31744
  s_waitcnt lgkmcnt(4)
  v_mfma_f32_16x16x32_bf16 v[52:55], v[200:203], v[104:107], v[52:55]
  ds_read_b128 v[220:223], v34 offset:30720
  s_waitcnt lgkmcnt(4)
  v_mfma_f32_16x16x32_bf16 v[56:59], v[204:207], v[104:107], v[56:59]
  ds_read_b128 v[224:227], v34 offset:31744
  s_waitcnt lgkmcnt(4)
  v_mfma_f32_16x16x32_bf16 v[60:63], v[208:211], v[104:107], v[60:63]
  ds_read_b128 v[228:231], v35 offset:30720
  s_waitcnt vmcnt(0)
  s_barrier
  s_waitcnt lgkmcnt(4)
  v_mfma_f32_16x16x32_bf16 v[44:47], v[212:215], v[108:111], v[44:47]
  ds_read_b128 v[192:195], v39 offset:0
  s_waitcnt lgkmcnt(4)
  v_mfma_f32_16x16x32_bf16 v[48:51], v[216:219], v[108:111], v[48:51]
  ds_read_b128 v[196:199], v39 offset:1024
  s_waitcnt lgkmcnt(4)
  v_mfma_f32_16x16x32_bf16 v[52:55], v[220:223], v[108:111], v[52:55]
  ds_read_b128 v[200:203], v40 offset:0
  s_waitcnt lgkmcnt(4)
  v_mfma_f32_16x16x32_bf16 v[56:59], v[224:227], v[108:111], v[56:59]
  ds_read_b128 v[204:207], v40 offset:1024
  s_waitcnt lgkmcnt(4)
  v_mfma_f32_16x16x32_bf16 v[60:63], v[228:231], v[108:111], v[60:63]
  ds_read_b128 v[208:211], v41 offset:0
  s_waitcnt lgkmcnt(4)
  v_mfma_f32_16x16x32_bf16 v[44:47], v[192:195], v[64:67], v[44:47]
  ds_read_b128 v[212:215], v39 offset:10240
  s_waitcnt lgkmcnt(4)
  v_mfma_f32_16x16x32_bf16 v[48:51], v[196:199], v[64:67], v[48:51]
  ds_read_b128 v[216:219], v39 offset:11264
  s_waitcnt lgkmcnt(4)
  v_mfma_f32_16x16x32_bf16 v[52:55], v[200:203], v[64:67], v[52:55]
  ds_read_b128 v[220:223], v40 offset:10240
  s_waitcnt lgkmcnt(4)
  v_mfma_f32_16x16x32_bf16 v[56:59], v[204:207], v[64:67], v[56:59]
  ds_read_b128 v[224:227], v40 offset:11264
  s_waitcnt lgkmcnt(4)
  v_mfma_f32_16x16x32_bf16 v[60:63], v[208:211], v[64:67], v[60:63]
  ds_read_b128 v[228:231], v41 offset:10240
  s_waitcnt lgkmcnt(4)
  v_mfma_f32_16x16x32_bf16 v[44:47], v[212:215], v[68:71], v[44:47]
  ds_read_b128 v[192:195], v39 offset:20480
  s_waitcnt lgkmcnt(4)
  v_mfma_f32_16x16x32_bf16 v[48:51], v[216:219], v[68:71], v[48:51]
  ds_read_b128 v[196:199], v39 offset:21504
  s_waitcnt lgkmcnt(4)
  v_mfma_f32_16x16x32_bf16 v[52:55], v[220:223], v[68:71], v[52:55]
  ds_read_b128 v[200:203], v40 offset:20480
  s_waitcnt lgkmcnt(4)
  v_mfma_f32_16x16x32_bf16 v[56:59], v[224:227], v[68:71], v[56:59]
  ds_read_b128 v[204:207], v40 offset:21504
  s_waitcnt lgkmcnt(4)
  v_mfma_f32_16x16x32_bf16 v[60:63], v[228:231], v[68:71], v[60:63]
  ds_read_b128 v[208:211], v41 offset:20480
  s_waitcnt lgkmcnt(2)
  v_mfma_f32_16x16x32_bf16 v[52:55], v[200:203], v[72:75], v[52:55]
  s_waitcnt lgkmcnt(1)
  v_mfma_f32_16x16x32_bf16 v[56:59], v[204:207], v[72:75], v[56:59]
  s_waitcnt lgkmcnt(0)
  v_mfma_f32_16x16x32_bf16 v[60:63], v[208:211], v[72:75], v[60:63]
  v_mfma_f32_16x16x32_bf16 v[44:47], v[192:195], v[72:75], v[44:47]
  v_mfma_f32_16x16x32_bf16 v[48:51], v[196:199], v[72:75], v[48:51]
  s_nop 1
  ds_write_b128 v42, v[52:55] offset:0
  s_nop 0
  ds_write_b128 v42, v[56:59] offset:1024
  s_nop 0
  ds_write_b128 v42, v[60:63] offset:2048
  s_waitcnt lgkmcnt(0)
  s_barrier
  ds_read_b128 v[112:115], v43 offset:0
  ds_read_b128 v[116:119], v43 offset:1024
  ds_read_b128 v[120:123], v43 offset:2048
  s_waitcnt lgkmcnt(2)
  v_pk_add_f32 v[44:45], v[44:45], v[112:113]
  v_pk_add_f32 v[46:47], v[46:47], v[114:115]
  v_cvt_pk_bf16_f32 v152, v44, v45
  v_cvt_pk_bf16_f32 v153, v46, v47
  s_waitcnt lgkmcnt(1)
  v_pk_add_f32 v[48:49], v[48:49], v[116:117]
  v_pk_add_f32 v[50:51], v[50:51], v[118:119]
  v_cvt_pk_bf16_f32 v154, v48, v49
  v_cvt_pk_bf16_f32 v155, v50, v51
  s_nop 0
  v_permlane16_swap_b32 v152, v154
  v_permlane16_swap_b32 v153, v155
  buffer_store_dwordx4 v[152:155], v17, s[56:59], s73 offen
  s_cbranch_vccnz L_fin
  s_waitcnt lgkmcnt(0)
  v_pk_add_f32 v[60:61], v[60:61], v[120:121]
  v_pk_add_f32 v[62:63], v[62:63], v[122:123]
  v_cvt_pk_bf16_f32 v156, v60, v61
  v_cvt_pk_bf16_f32 v157, v62, v63
  buffer_store_dwordx2 v[156:157], v3, s[56:59], s74 offen
L_fin:
L_end:
  s_endpgm
.section .rodata,"a"
.p2align 6
.amdhsa_kernel sequential_preLN__linear_attn_block__mixer_channel_mlp__prompt_kernel
  .amdhsa_next_free_vgpr 256
  .amdhsa_next_free_sgpr 102
  .amdhsa_accum_offset 256
  .amdhsa_group_segment_fixed_size 0
  .amdhsa_kernarg_size 88
  .amdhsa_user_sgpr_count 2
  .amdhsa_user_sgpr_kernarg_segment_ptr 1
  .amdhsa_system_sgpr_workgroup_id_x 1
.end_amdhsa_kernel
```
